```python
import torch

def _softmax(x, axis=-1):
    return torch.softmax(x, dim=axis)

def _gelu(x):
    return torch.nn.functional.gelu(x, approximate='tanh')

def _silu(x):
    return torch.nn.functional.silu(x)

def _sigmoid(x):
    return torch.sigmoid(x)

def _layernorm(x, axis=-1, eps=1e-05):
    m = x.mean(dim=axis, keepdim=True)
    v = x.var(dim=axis, keepdim=True, unbiased=False)
    return (x - m) / torch.sqrt(v + eps)

def _scatter_add(tgt, idx, src, axis=0):
    return tgt.clone().index_add_(axis, idx, src)

def _segment_sum(src, seg, n):
    out = torch.zeros((n,) + src.shape[1:], dtype=src.dtype)
    return out.index_add_(0, seg, src)

def _pad(x, pw):
    flat = tuple((v for pair in reversed(pw) for v in pair))
    return torch.nn.functional.pad(x, flat)
kernel_name = 'standalone__ragged_sequences_varlen_flash_attn__ragged'

def setup_inputs():

    _w = lambda a: (lambda t: t.to(torch.bfloat16) if t.is_floating_point() else t)(torch.as_tensor(a))
    cu = torch.tensor([0, 267, 391, 734, 1145, 1486, 1586, 1793, 1920, 2261, 2733, 2860, 2978, 3276, 3550, 4058, 4249], dtype=torch.int64)
    T = int(cu[-1])
    Hq, Hkv, D = (16, 4, 128)
    assert Hq % Hkv == 0
    return {'q': _w((lambda *s: torch.randn(*s, dtype=torch.bfloat16) * 0.8)(T, Hq, D)), 'k': _w((lambda *s: torch.randn(*s, dtype=torch.bfloat16) * 0.8)(T, Hkv, D)), 'v': _w((lambda *s: torch.randn(*s, dtype=torch.bfloat16) * 0.05)(T, Hkv, D)), 'cu': _w(cu)}

def reference(q, k, v, cu):
    T, Hq, D = q.shape
    Hkv = k.shape[1]
    rep = Hq // Hkv
    scale = D ** (-0.5)
    outs = []
    for i in range(len(cu) - 1):
        s, e = (int(cu[i]), int(cu[i + 1]))
        L = e - s
        qi = q[s:e].clone()
        ki = (lambda x, n, axis: torch.repeat_interleave(x, n, dim=axis))(k[s:e], rep, axis=1)
        vi = (lambda x, n, axis: torch.repeat_interleave(x, n, dim=axis))(v[s:e], rep, axis=1)
        logits = torch.einsum('qhd,khd->hqk', qi, ki) * scale
        ar = torch.arange(L)
        neg = (lambda x, dt: x.to(dt))(ar[None, :] > ar[:, None], logits.dtype) * -1000000000.0
        p = _softmax(logits + neg[None, :, :], axis=-1)
        outs.append(torch.einsum('hqk,khd->qhd', p, vi))
    return torch.concatenate(outs, axis=0)
```

```asm
; @launch grid=(512,1,1) block=(256,1,1) lds=77568
.amdgcn_target "amdgcn-amd-amdhsa--gfx950"
.text
.globl standalone__ragged_sequences_varlen_flash_attn__ragged_kernel
.p2align 8
.type standalone__ragged_sequences_varlen_flash_attn__ragged_kernel,@function
standalone__ragged_sequences_varlen_flash_attn__ragged_kernel:
    s_cmp_ge_u32 s2, 512
    s_cbranch_scc1 L_end
    s_getpc_b64 s[38:39]
L_pc:
    s_add_u32 s38, s38, L_table-L_pc
    s_addc_u32 s39, s39, 0
    s_lshl_b32 s31, s2, 3
    s_load_dwordx2 s[62:63], s[38:39], s31
    s_load_dwordx2 s[4:5], s[0:1], 0
    s_load_dwordx2 s[8:9], s[0:1], 8
    s_load_dwordx2 s[12:13], s[0:1], 16
    s_load_dwordx2 s[16:17], s[0:1], 32
    v_lshrrev_b32 v232, 6, v0
    v_and_b32 v236, 63, v0
    v_readfirstlane_b32 s21, v232
    s_mov_b32 s6, 0x1099000
    s_mov_b32 s7, 0x20000
    s_mov_b32 s10, 0x426400
    s_mov_b32 s11, 0x20000
    s_mov_b32 s14, 0x426400
    s_mov_b32 s15, 0x20000
    s_mov_b32 s18, 0x1099000
    s_mov_b32 s19, 0x20000
    s_mov_b32 s29, 0x3e0293ee
    s_mov_b32 s43, 17152
    v_lshrrev_b32 v232, 4, v236
    v_and_b32 v233, 15, v236
    v_lshlrev_b32 v227, 12, v232
    v_lshl_add_u32 v227, v233, 4, v227
    v_xor_b32 v234, v232, v233
    v_lshlrev_b32 v228, 8, v232
    v_lshl_add_u32 v228, v234, 4, v228
    v_and_b32 v234, 1, v232
    v_xor_b32 v233, v233, v234
    v_lshlrev_b32 v226, 13, v232
    v_lshl_add_u32 v226, v233, 4, v226
    s_mul_i32 s37, s21, 8704
    s_add_u32 s37, s37, 34304
    v_bfe_u32 v232, v236, 2, 3
    v_mul_u32_u24 v240, 1088, v232
    v_and_b32 v232, 3, v236
    v_mul_u32_u24 v232, 272, v232
    v_add3_u32 v240, v240, v232, s37
    v_lshrrev_b32 v232, 5, v236
    v_lshl_add_u32 v240, v232, 3, v240
    v_lshrrev_b32 v232, 5, v236
    v_bfe_u32 v233, v236, 3, 2
    v_and_b32 v234, 7, v236
    v_lshlrev_b32 v242, 12, v232
    v_lshl_add_u32 v242, v233, 8, v242
    v_lshl_add_u32 v242, v234, 4, v242
    v_mul_u32_u24 v241, 1088, v232
    v_lshl_add_u32 v241, v233, 8, v241
    v_xor_b32 v234, v234, v233
    v_lshl_add_u32 v241, v234, 4, v241
    v_add_u32 v241, s37, v241
    s_mul_i32 s26, s21, 2112
    s_mul_i32 s27, s21, 2176
    s_add_u32 s27, s27, 8448
    s_waitcnt lgkmcnt(0)
    s_mov_b32 s20, s62
    s_mov_b32 s60, s63
    s_mov_b32 s63, 0
L_item:
    s_and_b32 s35, s20, 0x1fff
    s_bfe_u32 s33, s20, 0x2000d
    s_bfe_u32 s22, s20, 0x50010
    s_bfe_u32 s34, s20, 0x60018
    s_cmp_eq_u32 s22, 0
    s_cbranch_scc1 L_end
    s_lshl_b32 s32, s33, 8
    s_lshl_b32 s23, s35, 10
    s_add_u32 s23, s23, s32
    s_lshl_b32 s31, s21, 11
    s_add_u32 s24, s23, s31
    s_and_b32 s25, s31, 0xc00
    s_lshr_b32 s31, s21, 1
    s_lshl_b32 s31, s31, 14
    s_add_u32 s25, s25, s31
    s_add_u32 s25, s25, s23
    s_lshl_b32 s41, s21, 3
    s_add_u32 s41, s41, s35
    s_lshl_b32 s30, s41, 12
    s_lshl_b32 s41, s33, 10
    s_add_u32 s30, s30, s41
    s_add_u32 s41, s35, s34
    s_lshl_b32 s6, s41, 12
    s_bitcmp1_b32 s20, 31
    s_cbranch_scc1 L_sync
    s_mov_b32 s28, 69120
    s_mov_b32 s41, s24
    s_add_u32 m0, s26, s28
    s_nop 0
    buffer_load_dwordx4 v226, s[8:11], s24 offen lds
    s_add_u32 m0, m0, 32
    s_nop 0
    buffer_load_dwordx4 v226, s[8:11], s24 offen offset:1024 lds
    s_sub_u32 s24, s41, 0x8000
    s_mov_b32 s41, s30
    s_mov_b32 m0, s37
    s_nop 0
    buffer_load_dwordx4 v228, s[4:7], s41 offen nt lds
    s_add_u32 s41, s41, 4096
    s_add_u32 m0, m0, 1088
    s_nop 0
    buffer_load_dwordx4 v228, s[4:7], s41 offen nt lds
    s_add_u32 s41, s41, 4096
    s_add_u32 m0, m0, 1088
    s_nop 0
    buffer_load_dwordx4 v228, s[4:7], s41 offen nt lds
    s_add_u32 s41, s41, 4096
    s_add_u32 m0, m0, 1088
    s_nop 0
    buffer_load_dwordx4 v228, s[4:7], s41 offen nt lds
    s_add_u32 s41, s41, 4096
    s_add_u32 m0, m0, 1088
    s_nop 0
    buffer_load_dwordx4 v228, s[4:7], s41 offen nt lds
    s_add_u32 s41, s41, 4096
    s_add_u32 m0, m0, 1088
    s_nop 0
    buffer_load_dwordx4 v228, s[4:7], s41 offen nt lds
    s_add_u32 s41, s41, 4096
    s_add_u32 m0, m0, 1088
    s_nop 0
    buffer_load_dwordx4 v228, s[4:7], s41 offen nt lds
    s_add_u32 s41, s41, 4096
    s_add_u32 m0, m0, 1088
    s_nop 0
    buffer_load_dwordx4 v228, s[4:7], s41 offen nt lds
    s_mov_b32 s28, 0
    s_cmp_lt_u32 s22, 2
    s_cbranch_scc1 L_i1U
    s_mov_b32 s41, s24
    s_add_u32 m0, s26, s28
    s_nop 0
    buffer_load_dwordx4 v226, s[8:11], s24 offen lds
    s_add_u32 m0, m0, 32
    s_nop 0
    buffer_load_dwordx4 v226, s[8:11], s24 offen offset:1024 lds
    s_sub_u32 s24, s41, 0x8000
L_i1U:
    s_mov_b32 s41, s25
    s_add_u32 m0, s27, s28
    s_nop 0
    buffer_load_dwordx4 v227, s[12:15], s25 offen lds
    s_add_u32 m0, m0, 64
    s_nop 0
    buffer_load_dwordx4 v227, s[12:15], s25 offen offset:1024 lds
    s_sub_u32 s25, s41, 0x8000
    s_mov_b32 s28, 17152
    s_cmp_lt_u32 s22, 2
    s_cbranch_scc1 L_i2U
    s_mov_b32 s41, s25
    s_add_u32 m0, s27, s28
    s_nop 0
    buffer_load_dwordx4 v227, s[12:15], s25 offen lds
    s_add_u32 m0, m0, 64
    s_nop 0
    buffer_load_dwordx4 v227, s[12:15], s25 offen offset:1024 lds
    s_sub_u32 s25, s41, 0x8000
    s_cmp_lt_u32 s22, 3
    s_cbranch_scc1 L_i2U
    s_mov_b32 s41, s24
    s_add_u32 m0, s26, s28
    s_nop 0
    buffer_load_dwordx4 v226, s[8:11], s24 offen lds
    s_add_u32 m0, m0, 32
    s_nop 0
    buffer_load_dwordx4 v226, s[8:11], s24 offen offset:1024 lds
    s_sub_u32 s24, s41, 0x8000
L_i2U:
    s_branch L_issued
L_sync:
    s_mov_b32 s28, 69120
    s_mov_b32 s41, s24
    s_add_u32 m0, s26, s28
    s_nop 0
    buffer_load_dwordx4 v226, s[8:11], s24 offen lds
    s_waitcnt vmcnt(6)
    s_add_u32 m0, m0, 32
    s_nop 0
    buffer_load_dwordx4 v226, s[8:11], s24 offen offset:1024 lds
    s_waitcnt vmcnt(6)
    s_sub_u32 s24, s41, 0x8000
    s_waitcnt vmcnt(0)
    s_mov_b32 s41, s30
    s_mov_b32 m0, s37
    s_nop 0
    buffer_load_dwordx4 v228, s[4:7], s41 offen nt lds
    s_waitcnt vmcnt(6)
    s_add_u32 s41, s41, 4096
    s_add_u32 m0, m0, 1088
    s_nop 0
    buffer_load_dwordx4 v228, s[4:7], s41 offen nt lds
    s_waitcnt vmcnt(6)
    s_add_u32 s41, s41, 4096
    s_add_u32 m0, m0, 1088
    s_nop 0
    buffer_load_dwordx4 v228, s[4:7], s41 offen nt lds
    s_waitcnt vmcnt(6)
    s_add_u32 s41, s41, 4096
    s_add_u32 m0, m0, 1088
    s_nop 0
    buffer_load_dwordx4 v228, s[4:7], s41 offen nt lds
    s_waitcnt vmcnt(6)
    s_add_u32 s41, s41, 4096
    s_add_u32 m0, m0, 1088
    s_nop 0
    buffer_load_dwordx4 v228, s[4:7], s41 offen nt lds
    s_waitcnt vmcnt(6)
    s_add_u32 s41, s41, 4096
    s_add_u32 m0, m0, 1088
    s_nop 0
    buffer_load_dwordx4 v228, s[4:7], s41 offen nt lds
    s_waitcnt vmcnt(6)
    s_add_u32 s41, s41, 4096
    s_add_u32 m0, m0, 1088
    s_nop 0
    buffer_load_dwordx4 v228, s[4:7], s41 offen nt lds
    s_waitcnt vmcnt(6)
    s_add_u32 s41, s41, 4096
    s_add_u32 m0, m0, 1088
    s_nop 0
    buffer_load_dwordx4 v228, s[4:7], s41 offen nt lds
    s_waitcnt vmcnt(6)
    s_mov_b32 s28, 0
    s_cmp_lt_u32 s22, 2
    s_cbranch_scc1 L_i1S
    s_mov_b32 s41, s24
    s_add_u32 m0, s26, s28
    s_nop 0
    buffer_load_dwordx4 v226, s[8:11], s24 offen lds
    s_waitcnt vmcnt(6)
    s_add_u32 m0, m0, 32
    s_nop 0
    buffer_load_dwordx4 v226, s[8:11], s24 offen offset:1024 lds
    s_waitcnt vmcnt(6)
    s_sub_u32 s24, s41, 0x8000
L_i1S:
    s_mov_b32 s41, s25
    s_add_u32 m0, s27, s28
    s_nop 0
    buffer_load_dwordx4 v227, s[12:15], s25 offen lds
    s_waitcnt vmcnt(6)
    s_add_u32 m0, m0, 64
    s_nop 0
    buffer_load_dwordx4 v227, s[12:15], s25 offen offset:1024 lds
    s_waitcnt vmcnt(6)
    s_sub_u32 s25, s41, 0x8000
    s_mov_b32 s28, 17152
    s_cmp_lt_u32 s22, 2
    s_cbranch_scc1 L_i2S
    s_mov_b32 s41, s25
    s_add_u32 m0, s27, s28
    s_nop 0
    buffer_load_dwordx4 v227, s[12:15], s25 offen lds
    s_waitcnt vmcnt(6)
    s_add_u32 m0, m0, 64
    s_nop 0
    buffer_load_dwordx4 v227, s[12:15], s25 offen offset:1024 lds
    s_waitcnt vmcnt(6)
    s_sub_u32 s25, s41, 0x8000
    s_cmp_lt_u32 s22, 3
    s_cbranch_scc1 L_i2S
    s_mov_b32 s41, s24
    s_add_u32 m0, s26, s28
    s_nop 0
    buffer_load_dwordx4 v226, s[8:11], s24 offen lds
    s_waitcnt vmcnt(6)
    s_add_u32 m0, m0, 32
    s_nop 0
    buffer_load_dwordx4 v226, s[8:11], s24 offen offset:1024 lds
    s_waitcnt vmcnt(6)
    s_sub_u32 s24, s41, 0x8000
L_i2S:
L_issued:
    v_lshrrev_b32 v234, 5, v236
    v_and_b32 v232, 7, v236
    v_mul_u32_u24 v224, 1056, v232
    v_bfe_u32 v232, v236, 3, 2
    v_lshl_add_u32 v224, v232, 8, v224
    v_and_b32 v232, 1, v232
    v_xor_b32 v232, v232, v234
    v_lshl_add_u32 v224, v232, 4, v224
    v_add_u32 v224, 69120, v224
    v_bfe_u32 v232, v236, 2, 2
    v_mul_u32_u24 v225, 1088, v232
    v_lshl_add_u32 v225, v234, 8, v225
    v_bfe_u32 v232, v236, 4, 1
    v_lshl_add_u32 v225, v232, 5, v225
    v_and_b32 v232, 3, v236
    v_lshl_add_u32 v225, v232, 3, v225
    v_add_u32 v225, 8448, v225
    v_bfe_u32 v232, v236, 2, 3
    v_mul_u32_u24 v229, 1088, v232
    v_and_b32 v233, 3, v236
    v_lshl_add_u32 v229, v233, 8, v229
    v_xor_b32 v233, v233, v234
    v_lshl_add_u32 v229, v233, 4, v229
    v_add_u32 v229, s37, v229
    v_xor_b32 v230, 32, v229
    v_lshlrev_b32 v233, 2, v234
    v_sub_u32 v231, v232, v233
    s_lshl_b32 s31, s21, 3
    v_add_u32 v231, s31, v231
    v_cmp_gt_i32 s[64:65], 0, v231
    v_cmp_gt_i32 s[66:67], 1, v231
    v_cmp_gt_i32 s[68:69], 2, v231
    v_cmp_gt_i32 s[70:71], 3, v231
    v_cmp_gt_i32 s[72:73], 8, v231
    v_cmp_gt_i32 s[74:75], 9, v231
    v_cmp_gt_i32 s[76:77], 10, v231
    v_cmp_gt_i32 s[78:79], 11, v231
    v_cmp_gt_i32 s[80:81], 16, v231
    v_cmp_gt_i32 s[82:83], 17, v231
    v_cmp_gt_i32 s[84:85], 18, v231
    v_cmp_gt_i32 s[86:87], 19, v231
    v_cmp_gt_i32 s[88:89], 24, v231
    v_cmp_gt_i32 s[90:91], 25, v231
    v_cmp_gt_i32 s[92:93], 26, v231
    v_cmp_gt_i32 s[94:95], 27, v231
    v_lshrrev_b32 v233, 4, v236
    v_lshrrev_b32 v232, 2, v236
    v_xor_b32 v232, v232, v233
    v_and_b32 v232, 1, v232
    v_cmp_eq_u32 vcc, 0, v232
    v_mov_b32 v233, 0x3f803f80
    v_mov_b32 v200, 0
    v_mov_b32 v201, 0
    v_mov_b32 v202, 0
    v_mov_b32 v203, 0
    v_cndmask_b32 v204, 0, v233, vcc
    v_cndmask_b32 v205, 0, v233, vcc
    v_cndmask_b32 v206, 0, v233, vcc
    v_cndmask_b32 v207, 0, v233, vcc
    v_mov_b32 v0, 0
    v_mov_b32 v1, 0
    v_mov_b32 v2, 0
    v_mov_b32 v3, 0
    v_mov_b32 v4, 0
    v_mov_b32 v5, 0
    v_mov_b32 v6, 0
    v_mov_b32 v7, 0
    v_mov_b32 v8, 0
    v_mov_b32 v9, 0
    v_mov_b32 v10, 0
    v_mov_b32 v11, 0
    v_mov_b32 v12, 0
    v_mov_b32 v13, 0
    v_mov_b32 v14, 0
    v_mov_b32 v15, 0
    v_mov_b32 v16, 0
    v_mov_b32 v17, 0
    v_mov_b32 v18, 0
    v_mov_b32 v19, 0
    v_mov_b32 v20, 0
    v_mov_b32 v21, 0
    v_mov_b32 v22, 0
    v_mov_b32 v23, 0
    v_mov_b32 v24, 0
    v_mov_b32 v25, 0
    v_mov_b32 v26, 0
    v_mov_b32 v27, 0
    v_mov_b32 v28, 0
    v_mov_b32 v29, 0
    v_mov_b32 v30, 0
    v_mov_b32 v31, 0
    v_mov_b32 v32, 0
    v_mov_b32 v33, 0
    v_mov_b32 v34, 0
    v_mov_b32 v35, 0
    v_mov_b32 v36, 0
    v_mov_b32 v37, 0
    v_mov_b32 v38, 0
    v_mov_b32 v39, 0
    v_mov_b32 v40, 0
    v_mov_b32 v41, 0
    v_mov_b32 v42, 0
    v_mov_b32 v43, 0
    v_mov_b32 v44, 0
    v_mov_b32 v45, 0
    v_mov_b32 v46, 0
    v_mov_b32 v47, 0
    v_mov_b32 v48, 0
    v_mov_b32 v49, 0
    v_mov_b32 v50, 0
    v_mov_b32 v51, 0
    v_mov_b32 v52, 0
    v_mov_b32 v53, 0
    v_mov_b32 v54, 0
    v_mov_b32 v55, 0
    v_mov_b32 v56, 0
    v_mov_b32 v57, 0
    v_mov_b32 v58, 0
    v_mov_b32 v59, 0
    v_mov_b32 v60, 0
    v_mov_b32 v61, 0
    v_mov_b32 v62, 0
    v_mov_b32 v63, 0
    s_cmp_lt_u32 s22, 3
    s_cbranch_scc1 L_w2
    s_waitcnt vmcnt(8)
    s_branch L_w8
L_w2:
    s_waitcnt vmcnt(2)
L_w8:
    ds_read_b128 v[64:67], v229 offset:0
    ds_read_b128 v[68:71], v230 offset:0
    ds_read_b128 v[72:75], v229 offset:64
    ds_read_b128 v[76:79], v230 offset:64
    ds_read_b128 v[80:83], v229 offset:128
    ds_read_b128 v[84:87], v230 offset:128
    ds_read_b128 v[88:91], v229 offset:192
    ds_read_b128 v[92:95], v230 offset:192
    s_barrier
    ds_read_b128 v[136:139], v224 offset:0
    ds_read_b128 v[140:143], v224 offset:32
    ds_read_b128 v[144:147], v224 offset:64
    ds_read_b128 v[148:151], v224 offset:96
    ds_read_b128 v[152:155], v224 offset:128
    ds_read_b128 v[156:159], v224 offset:160
    ds_read_b128 v[160:163], v224 offset:192
    ds_read_b128 v[164:167], v224 offset:224
    v_subrev_u32 v224, 69120, v224
    s_waitcnt lgkmcnt(7)
    v_mfma_f32_32x32x16_bf16 v[96:111], v[136:139], v[64:67], 0
    s_waitcnt lgkmcnt(6)
    v_mfma_f32_32x32x16_bf16 v[96:111], v[140:143], v[68:71], v[96:111]
    s_waitcnt lgkmcnt(5)
    v_mfma_f32_32x32x16_bf16 v[96:111], v[144:147], v[72:75], v[96:111]
    s_waitcnt lgkmcnt(4)
    v_mfma_f32_32x32x16_bf16 v[96:111], v[148:151], v[76:79], v[96:111]
    s_waitcnt lgkmcnt(3)
    v_mfma_f32_32x32x16_bf16 v[96:111], v[152:155], v[80:83], v[96:111]
    s_waitcnt lgkmcnt(2)
    v_mfma_f32_32x32x16_bf16 v[96:111], v[156:159], v[84:87], v[96:111]
    s_waitcnt lgkmcnt(1)
    v_mfma_f32_32x32x16_bf16 v[96:111], v[160:163], v[88:91], v[96:111]
    s_waitcnt lgkmcnt(0)
    v_mfma_f32_32x32x16_bf16 v[96:111], v[164:167], v[92:95], v[96:111]
    s_sub_u32 s40, s22, 1
    v_mov_b32 v232, 0xff800000
    s_nop 9
    v_cndmask_b32 v96, v96, v232, s[64:65]
    v_cndmask_b32 v97, v97, v232, s[66:67]
    v_cndmask_b32 v98, v98, v232, s[68:69]
    v_cndmask_b32 v99, v99, v232, s[70:71]
    v_cndmask_b32 v100, v100, v232, s[72:73]
    v_cndmask_b32 v101, v101, v232, s[74:75]
    v_cndmask_b32 v102, v102, v232, s[76:77]
    v_cndmask_b32 v103, v103, v232, s[78:79]
    v_cndmask_b32 v104, v104, v232, s[80:81]
    v_cndmask_b32 v105, v105, v232, s[82:83]
    v_cndmask_b32 v106, v106, v232, s[84:85]
    v_cndmask_b32 v107, v107, v232, s[86:87]
    v_cndmask_b32 v108, v108, v232, s[88:89]
    v_cndmask_b32 v109, v109, v232, s[90:91]
    v_cndmask_b32 v110, v110, v232, s[92:93]
    v_cndmask_b32 v111, v111, v232, s[94:95]
    v_max3_f32 v232, v96, v97, v98
    v_max3_f32 v233, v99, v100, v101
    v_max3_f32 v234, v102, v103, v104
    v_max3_f32 v235, v105, v106, v107
    v_max3_f32 v232, v232, v108, v109
    v_max3_f32 v233, v233, v110, v111
    v_max3_f32 v232, v232, v234, v235
    v_max_f32 v232, v232, v233
    v_mov_b32 v233, v232
    s_nop 1
    v_permlane32_swap_b32 v233, v232
    v_max_f32 v237, v232, v233
    v_mul_f32 v233, s29, v237
    v_fma_f32 v112, v96, s29, -v233
    v_fma_f32 v113, v97, s29, -v233
    v_fma_f32 v114, v98, s29, -v233
    v_fma_f32 v115, v99, s29, -v233
    v_fma_f32 v116, v100, s29, -v233
    v_fma_f32 v117, v101, s29, -v233
    v_fma_f32 v118, v102, s29, -v233
    v_fma_f32 v119, v103, s29, -v233
    v_fma_f32 v120, v104, s29, -v233
    v_fma_f32 v121, v105, s29, -v233
    v_fma_f32 v122, v106, s29, -v233
    v_fma_f32 v123, v107, s29, -v233
    v_fma_f32 v124, v108, s29, -v233
    v_fma_f32 v125, v109, s29, -v233
    v_fma_f32 v126, v110, s29, -v233
    v_fma_f32 v127, v111, s29, -v233
    v_mul_f32 v208, -1.0, v237
    v_mul_f32 v209, -1.0, v237
    v_mul_f32 v210, -1.0, v237
    v_mul_f32 v211, -1.0, v237
    v_mul_f32 v212, -1.0, v237
    v_mul_f32 v213, -1.0, v237
    v_mul_f32 v214, -1.0, v237
    v_mul_f32 v215, -1.0, v237
    v_mul_f32 v216, -1.0, v237
    v_mul_f32 v217, -1.0, v237
    v_mul_f32 v218, -1.0, v237
    v_mul_f32 v219, -1.0, v237
    v_mul_f32 v220, -1.0, v237
    v_mul_f32 v221, -1.0, v237
    v_mul_f32 v222, -1.0, v237
    v_mul_f32 v223, -1.0, v237
    s_waitcnt vmcnt(4)
    s_cmp_ge_u32 s22, 3
    s_cbranch_scc1 L_w4
    s_waitcnt vmcnt(0)
L_w4:
    s_barrier
    s_cmp_eq_u32 s63, 0
    s_cbranch_scc1 L_nopend
    s_mov_b32 s18, s62
    buffer_store_dwordx4 v[168:171], v242, s[16:19], s61 offen offset:0 sc0 sc1
    buffer_store_dwordx4 v[184:187], v242, s[16:19], s61 offen offset:128 sc0 sc1
    s_add_u32 s61, s61, 8192
    buffer_store_dwordx4 v[172:175], v242, s[16:19], s61 offen offset:0 sc0 sc1
    buffer_store_dwordx4 v[188:191], v242, s[16:19], s61 offen offset:128 sc0 sc1
    s_add_u32 s61, s61, 8192
    buffer_store_dwordx4 v[176:179], v242, s[16:19], s61 offen offset:0 sc0 sc1
    buffer_store_dwordx4 v[192:195], v242, s[16:19], s61 offen offset:128 sc0 sc1
    s_add_u32 s61, s61, 8192
    buffer_store_dwordx4 v[180:183], v242, s[16:19], s61 offen offset:0 sc0 sc1
    buffer_store_dwordx4 v[196:199], v242, s[16:19], s61 offen offset:128 sc0 sc1
L_nopend:
    s_cmp_eq_u32 s40, 0
    s_cbranch_scc1 L_tail
    ds_read_b128 v[136:139], v224 offset:0
    ds_read_b128 v[140:143], v224 offset:32
    ds_read_b128 v[144:147], v224 offset:64
    ds_read_b128 v[148:151], v224 offset:96
    s_mov_b32 s28, 34304
    s_cmp_lt_u32 s22, 3
    s_cbranch_scc1 L_pdone
    s_mov_b32 s41, s25
    s_add_u32 m0, s27, s28
    s_nop 0
    buffer_load_dwordx4 v227, s[12:15], s25 offen lds
    s_add_u32 m0, m0, 64
    s_nop 0
    buffer_load_dwordx4 v227, s[12:15], s25 offen offset:1024 lds
    s_sub_u32 s25, s41, 0x8000
    s_cmp_lt_u32 s22, 4
    s_cbranch_scc1 L_pdone
    s_mov_b32 s41, s24
    s_add_u32 m0, s26, s28
    s_nop 0
    buffer_load_dwordx4 v226, s[8:11], s24 offen lds
    s_add_u32 m0, m0, 32
    s_nop 0
    buffer_load_dwordx4 v226, s[8:11], s24 offen offset:1024 lds
    s_sub_u32 s24, s41, 0x8000
    s_mov_b32 s28, 51456
    s_cmp_lt_u32 s22, 4
    s_cbranch_scc1 L_pdone
    s_mov_b32 s41, s25
    s_add_u32 m0, s27, s28
    s_nop 0
    buffer_load_dwordx4 v227, s[12:15], s25 offen lds
    s_add_u32 m0, m0, 64
    s_nop 0
    buffer_load_dwordx4 v227, s[12:15], s25 offen offset:1024 lds
    s_sub_u32 s25, s41, 0x8000
    s_cmp_lt_u32 s22, 5
    s_cbranch_scc1 L_pdone
    s_mov_b32 s41, s24
    s_add_u32 m0, s26, s28
    s_nop 0
    buffer_load_dwordx4 v226, s[8:11], s24 offen lds
    s_add_u32 m0, m0, 32
    s_nop 0
    buffer_load_dwordx4 v226, s[8:11], s24 offen offset:1024 lds
    s_sub_u32 s24, s41, 0x8000
L_pdone:
    s_mov_b32 s28, 0
    s_cmp_lt_u32 s40, 4
    s_cbranch_scc1 L_drain
    s_cmp_eq_u32 s40, 4
    s_cbranch_scc1 L_d4
    s_sub_u32 s42, s40, 5
L_loop:
    s_waitcnt lgkmcnt(3)
    v_mfma_f32_32x32x16_bf16 v[96:111], v[136:139], v[64:67], v[208:223]
    s_waitcnt lgkmcnt(2)
    ds_read_b64_tr_b16 v[168:169], v225 offset:0
    ds_read_b128 v[152:155], v224 offset:128
    v_exp_f32 v112, v112
    v_exp_f32 v113, v113
    v_mfma_f32_32x32x16_bf16 v[96:111], v[140:143], v[68:71], v[96:111]
    s_waitcnt lgkmcnt(3)
    ds_read_b64_tr_b16 v[170:171], v225 offset:512
    ds_read_b128 v[156:159], v224 offset:160
    v_exp_f32 v114, v114
    v_exp_f32 v115, v115
    v_mfma_f32_32x32x16_bf16 v[96:111], v[144:147], v[72:75], v[96:111]
    s_waitcnt lgkmcnt(4)
    ds_read_b64_tr_b16 v[172:173], v225 offset:64
    ds_read_b128 v[160:163], v224 offset:192
    v_exp_f32 v116, v116
    v_exp_f32 v117, v117
    v_mfma_f32_32x32x16_bf16 v[96:111], v[148:151], v[76:79], v[96:111]
    s_waitcnt lgkmcnt(4)
    ds_read_b64_tr_b16 v[174:175], v225 offset:576
    ds_read_b128 v[164:167], v224 offset:224
    v_exp_f32 v118, v118
    v_exp_f32 v119, v119
    v_mfma_f32_32x32x16_bf16 v[96:111], v[152:155], v[80:83], v[96:111]
    s_waitcnt lgkmcnt(4)
    ds_read_b64_tr_b16 v[176:177], v225 offset:128
    ds_read_b64_tr_b16 v[178:179], v225 offset:640
    v_cvt_pk_bf16_f32 v128, v112, v113
    v_cvt_pk_bf16_f32 v129, v114, v115
    v_cvt_pk_bf16_f32 v130, v116, v117
    v_cvt_pk_bf16_f32 v131, v118, v119
    v_mfma_f32_32x32x16_bf16 v[96:111], v[156:159], v[84:87], v[96:111]
    s_waitcnt lgkmcnt(4)
    ds_read_b64_tr_b16 v[180:181], v225 offset:192
    ds_read_b64_tr_b16 v[182:183], v225 offset:704
    v_exp_f32 v120, v120
    v_exp_f32 v121, v121
    v_mfma_f32_32x32x16_bf16 v[96:111], v[160:163], v[88:91], v[96:111]
    s_waitcnt lgkmcnt(4)
    ds_read_b64_tr_b16 v[184:185], v225 offset:4352
    ds_read_b64_tr_b16 v[186:187], v225 offset:4864
    v_exp_f32 v122, v122
    v_exp_f32 v123, v123
    v_mfma_f32_32x32x16_bf16 v[96:111], v[164:167], v[92:95], v[96:111]
    s_waitcnt lgkmcnt(2)
    ds_read_b64_tr_b16 v[188:189], v225 offset:4416
    ds_read_b64_tr_b16 v[190:191], v225 offset:4928
    v_exp_f32 v124, v124
    v_exp_f32 v125, v125
    v_mfma_f32_32x32x16_bf16 v[0:15], v[168:171], v[128:131], v[0:15]
    s_cmp_eq_u32 s28, 51456
    ds_read_b64_tr_b16 v[192:193], v225 offset:4480
    ds_read_b64_tr_b16 v[194:195], v225 offset:4992
    v_exp_f32 v126, v126
    v_cvt_pk_bf16_f32 v132, v120, v121
    v_mfma_f32_32x32x16_bf16 v[16:31], v[172:175], v[128:131], v[16:31]
    s_cselect_b32 s36, 0xffff3700, s43
    ds_read_b64_tr_b16 v[196:197], v225 offset:4544
    ds_read_b64_tr_b16 v[198:199], v225 offset:5056
    v_exp_f32 v127, v127
    v_cvt_pk_bf16_f32 v133, v122, v123
    v_mfma_f32_32x32x16_bf16 v[32:47], v[176:179], v[128:131], v[32:47]
    s_add_u32 m0, s27, s28
    v_cvt_pk_bf16_f32 v134, v124, v125
    v_cvt_pk_bf16_f32 v135, v126, v127
    v_mul_f32 v112, s29, v96
    v_mul_f32 v113, s29, v97
    v_add_u32 v225, s36, v225
    v_add_u32 v224, s36, v224
    v_mfma_f32_32x32x16_bf16 v[48:63], v[180:183], v[128:131], v[48:63]
    s_waitcnt vmcnt(8) lgkmcnt(0)
    s_barrier
    v_mfma_f32_16x16x32_bf16 v[200:203], v[204:207], v[128:131], v[200:203]
    v_mul_f32 v114, s29, v98
    v_mul_f32 v115, s29, v99
    v_mfma_f32_32x32x16_bf16 v[0:15], v[184:187], v[132:135], v[0:15]
    buffer_load_dwordx4 v227, s[12:15], s25 offen lds
    s_add_u32 m0, m0, 64
    ds_read_b128 v[136:139], v224 offset:0
    v_mul_f32 v116, s29, v100
    v_mul_f32 v117, s29, v101
    v_mul_f32 v118, s29, v102
    v_mfma_f32_32x32x16_bf16 v[16:31], v[188:191], v[132:135], v[16:31]
    buffer_load_dwordx4 v227, s[12:15], s25 offen offset:1024 lds
    s_add_u32 m0, s26, s28
    ds_read_b128 v[140:143], v224 offset:32
    v_mul_f32 v119, s29, v103
    v_mul_f32 v120, s29, v104
    v_mul_f32 v121, s29, v105
    v_mfma_f32_32x32x16_bf16 v[32:47], v[192:195], v[132:135], v[32:47]
    buffer_load_dwordx4 v226, s[8:11], s24 offen lds
    s_add_u32 m0, m0, 32
    ds_read_b128 v[144:147], v224 offset:64
    v_mul_f32 v122, s29, v106
    v_mul_f32 v123, s29, v107
    v_mul_f32 v124, s29, v108
    v_mfma_f32_32x32x16_bf16 v[48:63], v[196:199], v[132:135], v[48:63]
    buffer_load_dwordx4 v226, s[8:11], s24 offen offset:1024 lds
    s_sub_u32 s25, s25, 0x8000
    ds_read_b128 v[148:151], v224 offset:96
    v_mul_f32 v125, s29, v109
    v_mul_f32 v126, s29, v110
    v_mul_f32 v127, s29, v111
    v_mfma_f32_16x16x32_bf16 v[200:203], v[204:207], v[132:135], v[200:203]
    s_sub_u32 s24, s24, 0x8000
    s_add_u32 s28, s28, s36
    s_sub_u32 s42, s42, 1
    s_cbranch_scc0 L_loop
    s_mov_b32 s40, 4
L_d4:
    s_waitcnt lgkmcnt(3)
    v_mfma_f32_32x32x16_bf16 v[96:111], v[136:139], v[64:67], v[208:223]
    s_waitcnt lgkmcnt(2)
    ds_read_b64_tr_b16 v[168:169], v225 offset:0
    ds_read_b128 v[152:155], v224 offset:128
    v_exp_f32 v112, v112
    v_exp_f32 v113, v113
    v_mfma_f32_32x32x16_bf16 v[96:111], v[140:143], v[68:71], v[96:111]
    s_waitcnt lgkmcnt(3)
    ds_read_b64_tr_b16 v[170:171], v225 offset:512
    ds_read_b128 v[156:159], v224 offset:160
    v_exp_f32 v114, v114
    v_exp_f32 v115, v115
    v_mfma_f32_32x32x16_bf16 v[96:111], v[144:147], v[72:75], v[96:111]
    s_waitcnt lgkmcnt(4)
    ds_read_b64_tr_b16 v[172:173], v225 offset:64
    ds_read_b128 v[160:163], v224 offset:192
    v_exp_f32 v116, v116
    v_exp_f32 v117, v117
    v_mfma_f32_32x32x16_bf16 v[96:111], v[148:151], v[76:79], v[96:111]
    s_waitcnt lgkmcnt(4)
    ds_read_b64_tr_b16 v[174:175], v225 offset:576
    ds_read_b128 v[164:167], v224 offset:224
    v_exp_f32 v118, v118
    v_exp_f32 v119, v119
    v_mfma_f32_32x32x16_bf16 v[96:111], v[152:155], v[80:83], v[96:111]
    s_waitcnt lgkmcnt(4)
    ds_read_b64_tr_b16 v[176:177], v225 offset:128
    ds_read_b64_tr_b16 v[178:179], v225 offset:640
    v_cvt_pk_bf16_f32 v128, v112, v113
    v_cvt_pk_bf16_f32 v129, v114, v115
    v_cvt_pk_bf16_f32 v130, v116, v117
    v_cvt_pk_bf16_f32 v131, v118, v119
    v_mfma_f32_32x32x16_bf16 v[96:111], v[156:159], v[84:87], v[96:111]
    s_waitcnt lgkmcnt(4)
    ds_read_b64_tr_b16 v[180:181], v225 offset:192
    ds_read_b64_tr_b16 v[182:183], v225 offset:704
    v_exp_f32 v120, v120
    v_exp_f32 v121, v121
    v_mfma_f32_32x32x16_bf16 v[96:111], v[160:163], v[88:91], v[96:111]
    s_waitcnt lgkmcnt(4)
    ds_read_b64_tr_b16 v[184:185], v225 offset:4352
    ds_read_b64_tr_b16 v[186:187], v225 offset:4864
    v_exp_f32 v122, v122
    v_exp_f32 v123, v123
    v_mfma_f32_32x32x16_bf16 v[96:111], v[164:167], v[92:95], v[96:111]
    s_waitcnt lgkmcnt(2)
    ds_read_b64_tr_b16 v[188:189], v225 offset:4416
    ds_read_b64_tr_b16 v[190:191], v225 offset:4928
    v_exp_f32 v124, v124
    v_exp_f32 v125, v125
    v_mfma_f32_32x32x16_bf16 v[0:15], v[168:171], v[128:131], v[0:15]
    s_cmp_eq_u32 s28, 51456
    ds_read_b64_tr_b16 v[192:193], v225 offset:4480
    ds_read_b64_tr_b16 v[194:195], v225 offset:4992
    v_exp_f32 v126, v126
    v_cvt_pk_bf16_f32 v132, v120, v121
    v_mfma_f32_32x32x16_bf16 v[16:31], v[172:175], v[128:131], v[16:31]
    s_cselect_b32 s36, 0xffff3700, s43
    ds_read_b64_tr_b16 v[196:197], v225 offset:4544
    ds_read_b64_tr_b16 v[198:199], v225 offset:5056
    v_exp_f32 v127, v127
    v_cvt_pk_bf16_f32 v133, v122, v123
    v_mfma_f32_32x32x16_bf16 v[32:47], v[176:179], v[128:131], v[32:47]
    s_add_u32 m0, s27, s28
    v_cvt_pk_bf16_f32 v134, v124, v125
    v_cvt_pk_bf16_f32 v135, v126, v127
    v_mul_f32 v112, s29, v96
    v_mul_f32 v113, s29, v97
    v_add_u32 v225, s36, v225
    v_add_u32 v224, s36, v224
    v_mfma_f32_32x32x16_bf16 v[48:63], v[180:183], v[128:131], v[48:63]
    s_waitcnt vmcnt(8) lgkmcnt(0)
    s_barrier
    v_mfma_f32_16x16x32_bf16 v[200:203], v[204:207], v[128:131], v[200:203]
    v_mul_f32 v114, s29, v98
    v_mul_f32 v115, s29, v99
    v_mfma_f32_32x32x16_bf16 v[0:15], v[184:187], v[132:135], v[0:15]
    buffer_load_dwordx4 v227, s[12:15], s25 offen lds
    s_add_u32 m0, m0, 64
    ds_read_b128 v[136:139], v224 offset:0
    v_mul_f32 v116, s29, v100
    v_mul_f32 v117, s29, v101
    v_mul_f32 v118, s29, v102
    v_mfma_f32_32x32x16_bf16 v[16:31], v[188:191], v[132:135], v[16:31]
    buffer_load_dwordx4 v227, s[12:15], s25 offen offset:1024 lds
    s_add_u32 s28, s28, s36
    ds_read_b128 v[140:143], v224 offset:32
    v_mul_f32 v119, s29, v103
    v_mul_f32 v120, s29, v104
    v_mul_f32 v121, s29, v105
    v_mfma_f32_32x32x16_bf16 v[32:47], v[192:195], v[132:135], v[32:47]
    s_mov_b32 s40, 3
    ds_read_b128 v[144:147], v224 offset:64
    v_mul_f32 v122, s29, v106
    v_mul_f32 v123, s29, v107
    v_mul_f32 v124, s29, v108
    v_mul_f32 v125, s29, v109
    v_mfma_f32_32x32x16_bf16 v[48:63], v[196:199], v[132:135], v[48:63]
    ds_read_b128 v[148:151], v224 offset:96
    v_mul_f32 v126, s29, v110
    v_mul_f32 v127, s29, v111
    v_mfma_f32_16x16x32_bf16 v[200:203], v[204:207], v[132:135], v[200:203]
L_drain:
    s_waitcnt lgkmcnt(3)
    v_mfma_f32_32x32x16_bf16 v[96:111], v[136:139], v[64:67], v[208:223]
    s_waitcnt lgkmcnt(2)
    ds_read_b64_tr_b16 v[168:169], v225 offset:0
    ds_read_b128 v[152:155], v224 offset:128
    v_exp_f32 v112, v112
    v_exp_f32 v113, v113
    v_mfma_f32_32x32x16_bf16 v[96:111], v[140:143], v[68:71], v[96:111]
    s_waitcnt lgkmcnt(3)
    ds_read_b64_tr_b16 v[170:171], v225 offset:512
    ds_read_b128 v[156:159], v224 offset:160
    v_exp_f32 v114, v114
    v_exp_f32 v115, v115
    v_mfma_f32_32x32x16_bf16 v[96:111], v[144:147], v[72:75], v[96:111]
    s_waitcnt lgkmcnt(4)
    ds_read_b64_tr_b16 v[172:173], v225 offset:64
    ds_read_b128 v[160:163], v224 offset:192
    v_exp_f32 v116, v116
    v_exp_f32 v117, v117
    v_mfma_f32_32x32x16_bf16 v[96:111], v[148:151], v[76:79], v[96:111]
    s_waitcnt lgkmcnt(4)
    ds_read_b64_tr_b16 v[174:175], v225 offset:576
    ds_read_b128 v[164:167], v224 offset:224
    v_exp_f32 v118, v118
    v_exp_f32 v119, v119
    v_mfma_f32_32x32x16_bf16 v[96:111], v[152:155], v[80:83], v[96:111]
    s_waitcnt lgkmcnt(4)
    ds_read_b64_tr_b16 v[176:177], v225 offset:128
    ds_read_b64_tr_b16 v[178:179], v225 offset:640
    v_cvt_pk_bf16_f32 v128, v112, v113
    v_cvt_pk_bf16_f32 v129, v114, v115
    v_cvt_pk_bf16_f32 v130, v116, v117
    v_cvt_pk_bf16_f32 v131, v118, v119
    v_mfma_f32_32x32x16_bf16 v[96:111], v[156:159], v[84:87], v[96:111]
    s_waitcnt lgkmcnt(4)
    ds_read_b64_tr_b16 v[180:181], v225 offset:192
    ds_read_b64_tr_b16 v[182:183], v225 offset:704
    v_exp_f32 v120, v120
    v_exp_f32 v121, v121
    v_mfma_f32_32x32x16_bf16 v[96:111], v[160:163], v[88:91], v[96:111]
    s_waitcnt lgkmcnt(4)
    ds_read_b64_tr_b16 v[184:185], v225 offset:4352
    ds_read_b64_tr_b16 v[186:187], v225 offset:4864
    v_exp_f32 v122, v122
    v_exp_f32 v123, v123
    v_mfma_f32_32x32x16_bf16 v[96:111], v[164:167], v[92:95], v[96:111]
    s_waitcnt lgkmcnt(2)
    ds_read_b64_tr_b16 v[188:189], v225 offset:4416
    ds_read_b64_tr_b16 v[190:191], v225 offset:4928
    v_exp_f32 v124, v124
    v_exp_f32 v125, v125
    v_mfma_f32_32x32x16_bf16 v[0:15], v[168:171], v[128:131], v[0:15]
    s_cmp_eq_u32 s28, 51456
    ds_read_b64_tr_b16 v[192:193], v225 offset:4480
    ds_read_b64_tr_b16 v[194:195], v225 offset:4992
    v_exp_f32 v126, v126
    v_cvt_pk_bf16_f32 v132, v120, v121
    v_mfma_f32_32x32x16_bf16 v[16:31], v[172:175], v[128:131], v[16:31]
    s_cselect_b32 s36, 0xffff3700, s43
    ds_read_b64_tr_b16 v[196:197], v225 offset:4544
    ds_read_b64_tr_b16 v[198:199], v225 offset:5056
    v_exp_f32 v127, v127
    v_cvt_pk_bf16_f32 v133, v122, v123
    v_mfma_f32_32x32x16_bf16 v[32:47], v[176:179], v[128:131], v[32:47]
    v_cvt_pk_bf16_f32 v134, v124, v125
    v_cvt_pk_bf16_f32 v135, v126, v127
    v_mul_f32 v112, s29, v96
    v_mul_f32 v113, s29, v97
    v_add_u32 v225, s36, v225
    v_add_u32 v224, s36, v224
    v_mfma_f32_32x32x16_bf16 v[48:63], v[180:183], v[128:131], v[48:63]
    s_waitcnt vmcnt(0) lgkmcnt(0)
    s_barrier
    v_mfma_f32_16x16x32_bf16 v[200:203], v[204:207], v[128:131], v[200:203]
    v_mul_f32 v114, s29, v98
    v_mul_f32 v115, s29, v99
    v_mfma_f32_32x32x16_bf16 v[0:15], v[184:187], v[132:135], v[0:15]
    s_add_u32 s28, s28, s36
    ds_read_b128 v[136:139], v224 offset:0
    v_mul_f32 v116, s29, v100
    v_mul_f32 v117, s29, v101
    v_mul_f32 v118, s29, v102
    v_mul_f32 v119, s29, v103
    v_mfma_f32_32x32x16_bf16 v[16:31], v[188:191], v[132:135], v[16:31]
    ds_read_b128 v[140:143], v224 offset:32
    v_mul_f32 v120, s29, v104
    v_mul_f32 v121, s29, v105
    v_mul_f32 v122, s29, v106
    v_mul_f32 v123, s29, v107
    v_mfma_f32_32x32x16_bf16 v[32:47], v[192:195], v[132:135], v[32:47]
    ds_read_b128 v[144:147], v224 offset:64
    v_mul_f32 v124, s29, v108
    v_mul_f32 v125, s29, v109
    v_mul_f32 v126, s29, v110
    v_mul_f32 v127, s29, v111
    v_mfma_f32_32x32x16_bf16 v[48:63], v[196:199], v[132:135], v[48:63]
    s_sub_u32 s40, s40, 1
    ds_read_b128 v[148:151], v224 offset:96
    v_mfma_f32_16x16x32_bf16 v[200:203], v[204:207], v[132:135], v[200:203]
    s_cmp_lg_u32 s40, 0
    s_cbranch_scc1 L_drain
L_tail:
    ds_read_b64_tr_b16 v[168:169], v225 offset:0
    ds_read_b64_tr_b16 v[170:171], v225 offset:512
    ds_read_b64_tr_b16 v[172:173], v225 offset:64
    ds_read_b64_tr_b16 v[174:175], v225 offset:576
    ds_read_b64_tr_b16 v[176:177], v225 offset:128
    ds_read_b64_tr_b16 v[178:179], v225 offset:640
    ds_read_b64_tr_b16 v[180:181], v225 offset:192
    ds_read_b64_tr_b16 v[182:183], v225 offset:704
    v_exp_f32 v112, v112
    v_exp_f32 v113, v113
    v_exp_f32 v114, v114
    v_exp_f32 v115, v115
    v_cvt_pk_bf16_f32 v128, v112, v113
    v_cvt_pk_bf16_f32 v129, v114, v115
    v_exp_f32 v116, v116
    v_exp_f32 v117, v117
    v_exp_f32 v118, v118
    v_exp_f32 v119, v119
    ds_read_b64_tr_b16 v[184:185], v225 offset:4352
    ds_read_b64_tr_b16 v[186:187], v225 offset:4864
    ds_read_b64_tr_b16 v[188:189], v225 offset:4416
    ds_read_b64_tr_b16 v[190:191], v225 offset:4928
    ds_read_b64_tr_b16 v[192:193], v225 offset:4480
    ds_read_b64_tr_b16 v[194:195], v225 offset:4992
    ds_read_b64_tr_b16 v[196:197], v225 offset:4544
    ds_read_b64_tr_b16 v[198:199], v225 offset:5056
    v_cvt_pk_bf16_f32 v130, v116, v117
    v_cvt_pk_bf16_f32 v131, v118, v119
    s_waitcnt lgkmcnt(8)
    s_nop 0
    v_mfma_f32_32x32x16_bf16 v[0:15], v[168:171], v[128:131], v[0:15]
    v_exp_f32 v120, v120
    v_exp_f32 v121, v121
    v_exp_f32 v122, v122
    v_mfma_f32_32x32x16_bf16 v[16:31], v[172:175], v[128:131], v[16:31]
    v_exp_f32 v123, v123
    v_cvt_pk_bf16_f32 v132, v120, v121
    v_cvt_pk_bf16_f32 v133, v122, v123
    v_exp_f32 v124, v124
    v_mfma_f32_32x32x16_bf16 v[32:47], v[176:179], v[128:131], v[32:47]
    v_exp_f32 v125, v125
    v_exp_f32 v126, v126
    v_exp_f32 v127, v127
    v_mfma_f32_32x32x16_bf16 v[48:63], v[180:183], v[128:131], v[48:63]
    v_cvt_pk_bf16_f32 v134, v124, v125
    v_cvt_pk_bf16_f32 v135, v126, v127
    v_mfma_f32_16x16x32_bf16 v[200:203], v[204:207], v[128:131], v[200:203]
    s_nop 0
    v_mfma_f32_16x16x32_bf16 v[200:203], v[204:207], v[132:135], v[200:203]
    s_waitcnt lgkmcnt(0)
    v_mfma_f32_32x32x16_bf16 v[0:15], v[184:187], v[132:135], v[0:15]
    s_barrier
    s_mov_b32 s31, 0x4b800000
    v_mfma_f32_32x32x16_bf16 v[16:31], v[188:191], v[132:135], v[16:31]
    v_xor_b32 v233, 16, v240
    v_xor_b32 v234, 32, v240
    v_xor_b32 v235, 48, v240
    v_cmp_nge_f32 vcc, s31, v200
    v_mfma_f32_32x32x16_bf16 v[32:47], v[192:195], v[132:135], v[32:47]
    v_rcp_f32 v237, v200
    v_mfma_f32_32x32x16_bf16 v[48:63], v[196:199], v[132:135], v[48:63]
    s_cbranch_vccnz L_slow
L_norm:
    v_mov_b32 v244, v237
    s_mov_b32 s61, s30
    s_mov_b32 s62, s6
    v_pk_mul_f32 v[0:1], v[244:245], v[0:1] op_sel_hi:[0,1]
    v_pk_mul_f32 v[2:3], v[244:245], v[2:3] op_sel_hi:[0,1]
    v_pk_mul_f32 v[4:5], v[244:245], v[4:5] op_sel_hi:[0,1]
    v_pk_mul_f32 v[6:7], v[244:245], v[6:7] op_sel_hi:[0,1]
    v_pk_mul_f32 v[8:9], v[244:245], v[8:9] op_sel_hi:[0,1]
    v_pk_mul_f32 v[10:11], v[244:245], v[10:11] op_sel_hi:[0,1]
    v_pk_mul_f32 v[12:13], v[244:245], v[12:13] op_sel_hi:[0,1]
    v_pk_mul_f32 v[14:15], v[244:245], v[14:15] op_sel_hi:[0,1]
    v_cvt_pk_bf16_f32 v136, v0, v1
    v_cvt_pk_bf16_f32 v137, v2, v3
    v_cvt_pk_bf16_f32 v138, v4, v5
    v_cvt_pk_bf16_f32 v139, v6, v7
    v_cvt_pk_bf16_f32 v140, v8, v9
    v_cvt_pk_bf16_f32 v141, v10, v11
    v_cvt_pk_bf16_f32 v142, v12, v13
    v_cvt_pk_bf16_f32 v143, v14, v15
    ds_write_b64 v240, v[136:137] offset:0
    ds_write_b64 v233, v[138:139] offset:0
    ds_write_b64 v234, v[140:141] offset:0
    ds_write_b64 v235, v[142:143] offset:0
    v_pk_mul_f32 v[16:17], v[244:245], v[16:17] op_sel_hi:[0,1]
    v_pk_mul_f32 v[18:19], v[244:245], v[18:19] op_sel_hi:[0,1]
    v_pk_mul_f32 v[20:21], v[244:245], v[20:21] op_sel_hi:[0,1]
    v_pk_mul_f32 v[22:23], v[244:245], v[22:23] op_sel_hi:[0,1]
    v_pk_mul_f32 v[24:25], v[244:245], v[24:25] op_sel_hi:[0,1]
    v_pk_mul_f32 v[26:27], v[244:245], v[26:27] op_sel_hi:[0,1]
    v_pk_mul_f32 v[28:29], v[244:245], v[28:29] op_sel_hi:[0,1]
    v_pk_mul_f32 v[30:31], v[244:245], v[30:31] op_sel_hi:[0,1]
    v_cvt_pk_bf16_f32 v144, v16, v17
    v_cvt_pk_bf16_f32 v145, v18, v19
    v_cvt_pk_bf16_f32 v146, v20, v21
    v_cvt_pk_bf16_f32 v147, v22, v23
    v_cvt_pk_bf16_f32 v148, v24, v25
    v_cvt_pk_bf16_f32 v149, v26, v27
    v_cvt_pk_bf16_f32 v150, v28, v29
    v_cvt_pk_bf16_f32 v151, v30, v31
    ds_write_b64 v240, v[144:145] offset:64
    ds_write_b64 v233, v[146:147] offset:64
    ds_write_b64 v234, v[148:149] offset:64
    ds_write_b64 v235, v[150:151] offset:64
    s_waitcnt lgkmcnt(0)
    ds_read_b128 v[168:171], v241 offset:0
    ds_read_b128 v[172:175], v241 offset:2176
    ds_read_b128 v[176:179], v241 offset:4352
    ds_read_b128 v[180:183], v241 offset:6528
    v_pk_mul_f32 v[32:33], v[244:245], v[32:33] op_sel_hi:[0,1]
    v_pk_mul_f32 v[34:35], v[244:245], v[34:35] op_sel_hi:[0,1]
    v_pk_mul_f32 v[36:37], v[244:245], v[36:37] op_sel_hi:[0,1]
    v_pk_mul_f32 v[38:39], v[244:245], v[38:39] op_sel_hi:[0,1]
    v_pk_mul_f32 v[40:41], v[244:245], v[40:41] op_sel_hi:[0,1]
    v_pk_mul_f32 v[42:43], v[244:245], v[42:43] op_sel_hi:[0,1]
    v_pk_mul_f32 v[44:45], v[244:245], v[44:45] op_sel_hi:[0,1]
    v_pk_mul_f32 v[46:47], v[244:245], v[46:47] op_sel_hi:[0,1]
    v_cvt_pk_bf16_f32 v152, v32, v33
    v_cvt_pk_bf16_f32 v153, v34, v35
    v_cvt_pk_bf16_f32 v154, v36, v37
    v_cvt_pk_bf16_f32 v155, v38, v39
    v_cvt_pk_bf16_f32 v156, v40, v41
    v_cvt_pk_bf16_f32 v157, v42, v43
    v_cvt_pk_bf16_f32 v158, v44, v45
    v_cvt_pk_bf16_f32 v159, v46, v47
    ds_write_b64 v240, v[152:153] offset:128
    ds_write_b64 v233, v[154:155] offset:128
    ds_write_b64 v234, v[156:157] offset:128
    ds_write_b64 v235, v[158:159] offset:128
    s_cmp_lg_u32 s60, 0
    s_cbranch_scc1 L_next
    s_mov_b32 s18, s62
    s_mov_b32 s41, s61
    s_waitcnt lgkmcnt(4)
    buffer_store_dwordx4 v[168:171], v242, s[16:19], s61 offen offset:0 sc0 sc1
    s_add_u32 s61, s61, 8192
    buffer_store_dwordx4 v[172:175], v242, s[16:19], s61 offen offset:0 sc0 sc1
    s_add_u32 s61, s61, 8192
    buffer_store_dwordx4 v[176:179], v242, s[16:19], s61 offen offset:0 sc0 sc1
    s_add_u32 s61, s61, 8192
    buffer_store_dwordx4 v[180:183], v242, s[16:19], s61 offen offset:0 sc0 sc1
    v_pk_mul_f32 v[48:49], v[244:245], v[48:49] op_sel_hi:[0,1]
    v_pk_mul_f32 v[50:51], v[244:245], v[50:51] op_sel_hi:[0,1]
    v_pk_mul_f32 v[52:53], v[244:245], v[52:53] op_sel_hi:[0,1]
    v_pk_mul_f32 v[54:55], v[244:245], v[54:55] op_sel_hi:[0,1]
    v_pk_mul_f32 v[56:57], v[244:245], v[56:57] op_sel_hi:[0,1]
    v_pk_mul_f32 v[58:59], v[244:245], v[58:59] op_sel_hi:[0,1]
    v_pk_mul_f32 v[60:61], v[244:245], v[60:61] op_sel_hi:[0,1]
    v_pk_mul_f32 v[62:63], v[244:245], v[62:63] op_sel_hi:[0,1]
    v_cvt_pk_bf16_f32 v160, v48, v49
    v_cvt_pk_bf16_f32 v161, v50, v51
    v_cvt_pk_bf16_f32 v162, v52, v53
    v_cvt_pk_bf16_f32 v163, v54, v55
    v_cvt_pk_bf16_f32 v164, v56, v57
    v_cvt_pk_bf16_f32 v165, v58, v59
    v_cvt_pk_bf16_f32 v166, v60, v61
    v_cvt_pk_bf16_f32 v167, v62, v63
    ds_write_b64 v240, v[160:161] offset:192
    ds_write_b64 v233, v[162:163] offset:192
    ds_write_b64 v234, v[164:165] offset:192
    ds_write_b64 v235, v[166:167] offset:192
    s_waitcnt lgkmcnt(0)
    ds_read_b128 v[184:187], v241 offset:128
    ds_read_b128 v[188:191], v241 offset:2304
    ds_read_b128 v[192:195], v241 offset:4480
    ds_read_b128 v[196:199], v241 offset:6656
    s_mov_b32 s61, s41
    s_waitcnt lgkmcnt(3)
    buffer_store_dwordx4 v[184:187], v242, s[16:19], s61 offen offset:128 sc0 sc1
    s_add_u32 s61, s61, 8192
    s_waitcnt lgkmcnt(2)
    buffer_store_dwordx4 v[188:191], v242, s[16:19], s61 offen offset:128 sc0 sc1
    s_add_u32 s61, s61, 8192
    s_waitcnt lgkmcnt(1)
    buffer_store_dwordx4 v[192:195], v242, s[16:19], s61 offen offset:128 sc0 sc1
    s_add_u32 s61, s61, 8192
    s_waitcnt lgkmcnt(0)
    buffer_store_dwordx4 v[196:199], v242, s[16:19], s61 offen offset:128 sc0 sc1
L_end:
    s_endpgm
L_next:
    v_pk_mul_f32 v[48:49], v[244:245], v[48:49] op_sel_hi:[0,1]
    v_pk_mul_f32 v[50:51], v[244:245], v[50:51] op_sel_hi:[0,1]
    v_pk_mul_f32 v[52:53], v[244:245], v[52:53] op_sel_hi:[0,1]
    v_pk_mul_f32 v[54:55], v[244:245], v[54:55] op_sel_hi:[0,1]
    v_pk_mul_f32 v[56:57], v[244:245], v[56:57] op_sel_hi:[0,1]
    v_pk_mul_f32 v[58:59], v[244:245], v[58:59] op_sel_hi:[0,1]
    v_pk_mul_f32 v[60:61], v[244:245], v[60:61] op_sel_hi:[0,1]
    v_pk_mul_f32 v[62:63], v[244:245], v[62:63] op_sel_hi:[0,1]
    v_cvt_pk_bf16_f32 v160, v48, v49
    v_cvt_pk_bf16_f32 v161, v50, v51
    v_cvt_pk_bf16_f32 v162, v52, v53
    v_cvt_pk_bf16_f32 v163, v54, v55
    v_cvt_pk_bf16_f32 v164, v56, v57
    v_cvt_pk_bf16_f32 v165, v58, v59
    v_cvt_pk_bf16_f32 v166, v60, v61
    v_cvt_pk_bf16_f32 v167, v62, v63
    ds_write_b64 v240, v[160:161] offset:192
    ds_write_b64 v233, v[162:163] offset:192
    ds_write_b64 v234, v[164:165] offset:192
    ds_write_b64 v235, v[166:167] offset:192
    s_waitcnt lgkmcnt(0)
    ds_read_b128 v[184:187], v241 offset:128
    ds_read_b128 v[188:191], v241 offset:2304
    ds_read_b128 v[192:195], v241 offset:4480
    ds_read_b128 v[196:199], v241 offset:6656
    s_mov_b32 s20, s60
    s_mov_b32 s60, 0
    s_mov_b32 s63, 1
    s_setprio 0
    s_waitcnt lgkmcnt(0)
    s_branch L_item
L_slow:
    s_nop 15
    v_lshrrev_b32 v234, 5, v236
    v_and_b32 v232, 7, v236
    v_mul_u32_u24 v208, 1056, v232
    v_bfe_u32 v232, v236, 3, 2
    v_lshl_add_u32 v208, v232, 8, v208
    v_and_b32 v232, 1, v232
    v_xor_b32 v232, v232, v234
    v_lshl_add_u32 v208, v232, 4, v208
    v_add_u32 v208, s37, v208
    v_bfe_u32 v232, v236, 2, 2
    v_mul_u32_u24 v209, 1088, v232
    v_lshl_add_u32 v209, v234, 8, v209
    v_bfe_u32 v232, v236, 4, 1
    v_lshl_add_u32 v209, v232, 5, v209
    v_and_b32 v232, 3, v236
    v_lshl_add_u32 v209, v232, 3, v209
    v_add_u32 v209, s37, v209
    v_mov_b32 v0, 0
    v_mov_b32 v1, 0
    v_mov_b32 v2, 0
    v_mov_b32 v3, 0
    v_mov_b32 v4, 0
    v_mov_b32 v5, 0
    v_mov_b32 v6, 0
    v_mov_b32 v7, 0
    v_mov_b32 v8, 0
    v_mov_b32 v9, 0
    v_mov_b32 v10, 0
    v_mov_b32 v11, 0
    v_mov_b32 v12, 0
    v_mov_b32 v13, 0
    v_mov_b32 v14, 0
    v_mov_b32 v15, 0
    v_mov_b32 v16, 0
    v_mov_b32 v17, 0
    v_mov_b32 v18, 0
    v_mov_b32 v19, 0
    v_mov_b32 v20, 0
    v_mov_b32 v21, 0
    v_mov_b32 v22, 0
    v_mov_b32 v23, 0
    v_mov_b32 v24, 0
    v_mov_b32 v25, 0
    v_mov_b32 v26, 0
    v_mov_b32 v27, 0
    v_mov_b32 v28, 0
    v_mov_b32 v29, 0
    v_mov_b32 v30, 0
    v_mov_b32 v31, 0
    v_mov_b32 v32, 0
    v_mov_b32 v33, 0
    v_mov_b32 v34, 0
    v_mov_b32 v35, 0
    v_mov_b32 v36, 0
    v_mov_b32 v37, 0
    v_mov_b32 v38, 0
    v_mov_b32 v39, 0
    v_mov_b32 v40, 0
    v_mov_b32 v41, 0
    v_mov_b32 v42, 0
    v_mov_b32 v43, 0
    v_mov_b32 v44, 0
    v_mov_b32 v45, 0
    v_mov_b32 v46, 0
    v_mov_b32 v47, 0
    v_mov_b32 v48, 0
    v_mov_b32 v49, 0
    v_mov_b32 v50, 0
    v_mov_b32 v51, 0
    v_mov_b32 v52, 0
    v_mov_b32 v53, 0
    v_mov_b32 v54, 0
    v_mov_b32 v55, 0
    v_mov_b32 v56, 0
    v_mov_b32 v57, 0
    v_mov_b32 v58, 0
    v_mov_b32 v59, 0
    v_mov_b32 v60, 0
    v_mov_b32 v61, 0
    v_mov_b32 v62, 0
    v_mov_b32 v63, 0
    v_mov_b32 v200, 0
    v_mov_b32 v201, 0
    v_mov_b32 v202, 0
    v_mov_b32 v203, 0
    v_mov_b32 v237, 0xff800000
    s_mov_b32 s42, 0
L_slow_loop:
    s_mov_b32 s41, s23
    s_mov_b32 m0, s37
    s_nop 0
    buffer_load_dwordx4 v226, s[8:11], s41 offen lds
    s_add_u32 s41, s41, 1024
    s_add_u32 m0, m0, 1056
    s_nop 0
    buffer_load_dwordx4 v226, s[8:11], s41 offen lds
    s_add_u32 s41, s41, 1024
    s_add_u32 m0, m0, 1056
    s_nop 0
    buffer_load_dwordx4 v226, s[8:11], s41 offen lds
    s_add_u32 s41, s41, 1024
    s_add_u32 m0, m0, 1056
    s_nop 0
    buffer_load_dwordx4 v226, s[8:11], s41 offen lds
    s_add_u32 s41, s41, 1024
    s_add_u32 m0, m0, 1056
    s_nop 0
    buffer_load_dwordx4 v226, s[8:11], s41 offen lds
    s_add_u32 s41, s41, 1024
    s_add_u32 m0, m0, 1056
    s_nop 0
    buffer_load_dwordx4 v226, s[8:11], s41 offen lds
    s_add_u32 s41, s41, 1024
    s_add_u32 m0, m0, 1056
    s_nop 0
    buffer_load_dwordx4 v226, s[8:11], s41 offen lds
    s_add_u32 s41, s41, 1024
    s_add_u32 m0, m0, 1056
    s_nop 0
    buffer_load_dwordx4 v226, s[8:11], s41 offen lds
    s_add_u32 s41, s41, 1024
    s_add_u32 m0, m0, 1056
    s_waitcnt vmcnt(0)
    ds_read_b128 v[136:139], v208 offset:0
    ds_read_b128 v[140:143], v208 offset:32
    ds_read_b128 v[144:147], v208 offset:64
    ds_read_b128 v[148:151], v208 offset:96
    ds_read_b128 v[152:155], v208 offset:128
    ds_read_b128 v[156:159], v208 offset:160
    ds_read_b128 v[160:163], v208 offset:192
    ds_read_b128 v[164:167], v208 offset:224
    s_waitcnt lgkmcnt(0)
    v_mfma_f32_32x32x16_bf16 v[96:111], v[136:139], v[64:67], 0
    v_mfma_f32_32x32x16_bf16 v[96:111], v[140:143], v[68:71], v[96:111]
    v_mfma_f32_32x32x16_bf16 v[96:111], v[144:147], v[72:75], v[96:111]
    v_mfma_f32_32x32x16_bf16 v[96:111], v[148:151], v[76:79], v[96:111]
    v_mfma_f32_32x32x16_bf16 v[96:111], v[152:155], v[80:83], v[96:111]
    v_mfma_f32_32x32x16_bf16 v[96:111], v[156:159], v[84:87], v[96:111]
    v_mfma_f32_32x32x16_bf16 v[96:111], v[160:163], v[88:91], v[96:111]
    v_mfma_f32_32x32x16_bf16 v[96:111], v[164:167], v[92:95], v[96:111]
    s_mov_b32 m0, s37
    s_add_u32 s41, s23, 0
    buffer_load_dwordx4 v227, s[12:15], s41 offen lds
    s_add_u32 m0, m0, 1088
    s_add_u32 s41, s23, 1024
    buffer_load_dwordx4 v227, s[12:15], s41 offen lds
    s_add_u32 m0, m0, 1088
    s_add_u32 s41, s23, 2048
    buffer_load_dwordx4 v227, s[12:15], s41 offen lds
    s_add_u32 m0, m0, 1088
    s_add_u32 s41, s23, 3072
    buffer_load_dwordx4 v227, s[12:15], s41 offen lds
    s_add_u32 m0, m0, 1088
    s_add_u32 s41, s23, 16384
    buffer_load_dwordx4 v227, s[12:15], s41 offen lds
    s_add_u32 m0, m0, 1088
    s_add_u32 s41, s23, 17408
    buffer_load_dwordx4 v227, s[12:15], s41 offen lds
    s_add_u32 m0, m0, 1088
    s_add_u32 s41, s23, 18432
    buffer_load_dwordx4 v227, s[12:15], s41 offen lds
    s_add_u32 m0, m0, 1088
    s_add_u32 s41, s23, 19456
    buffer_load_dwordx4 v227, s[12:15], s41 offen lds
    s_add_u32 m0, m0, 1088
    s_cmp_lg_u32 s42, 0
    s_cbranch_scc1 L_slow_nomask
    s_nop 7
    v_mov_b32 v232, 0xff800000
    v_cndmask_b32 v96, v96, v232, s[64:65]
    v_cndmask_b32 v97, v97, v232, s[66:67]
    v_cndmask_b32 v98, v98, v232, s[68:69]
    v_cndmask_b32 v99, v99, v232, s[70:71]
    v_cndmask_b32 v100, v100, v232, s[72:73]
    v_cndmask_b32 v101, v101, v232, s[74:75]
    v_cndmask_b32 v102, v102, v232, s[76:77]
    v_cndmask_b32 v103, v103, v232, s[78:79]
    v_cndmask_b32 v104, v104, v232, s[80:81]
    v_cndmask_b32 v105, v105, v232, s[82:83]
    v_cndmask_b32 v106, v106, v232, s[84:85]
    v_cndmask_b32 v107, v107, v232, s[86:87]
    v_cndmask_b32 v108, v108, v232, s[88:89]
    v_cndmask_b32 v109, v109, v232, s[90:91]
    v_cndmask_b32 v110, v110, v232, s[92:93]
    v_cndmask_b32 v111, v111, v232, s[94:95]
L_slow_nomask:
    v_max3_f32 v232, v96, v97, v98
    v_max3_f32 v233, v99, v100, v101
    v_max3_f32 v234, v102, v103, v104
    v_max3_f32 v235, v105, v106, v107
    v_max3_f32 v232, v232, v108, v109
    v_max3_f32 v233, v233, v110, v111
    v_max3_f32 v232, v232, v234, v235
    v_max_f32 v232, v232, v233
    v_mov_b32 v233, v232
    s_nop 1
    v_permlane32_swap_b32 v233, v232
    v_max_f32 v210, v232, v233
    v_max_f32 v211, v210, v237
    v_sub_f32 v210, v237, v211
    v_mul_f32 v210, s29, v210
    v_exp_f32 v210, v210
    v_mov_b32 v237, v211
    v_mul_f32 v211, s29, v211
    v_fma_f32 v112, v96, s29, -v211
    v_fma_f32 v113, v97, s29, -v211
    v_fma_f32 v114, v98, s29, -v211
    v_fma_f32 v115, v99, s29, -v211
    v_fma_f32 v116, v100, s29, -v211
    v_fma_f32 v117, v101, s29, -v211
    v_fma_f32 v118, v102, s29, -v211
    v_fma_f32 v119, v103, s29, -v211
    v_fma_f32 v120, v104, s29, -v211
    v_fma_f32 v121, v105, s29, -v211
    v_fma_f32 v122, v106, s29, -v211
    v_fma_f32 v123, v107, s29, -v211
    v_fma_f32 v124, v108, s29, -v211
    v_fma_f32 v125, v109, s29, -v211
    v_fma_f32 v126, v110, s29, -v211
    v_fma_f32 v127, v111, s29, -v211
    v_exp_f32 v112, v112
    v_exp_f32 v113, v113
    v_exp_f32 v114, v114
    v_exp_f32 v115, v115
    v_exp_f32 v116, v116
    v_exp_f32 v117, v117
    v_exp_f32 v118, v118
    v_exp_f32 v119, v119
    v_exp_f32 v120, v120
    v_exp_f32 v121, v121
    v_exp_f32 v122, v122
    v_exp_f32 v123, v123
    v_exp_f32 v124, v124
    v_exp_f32 v125, v125
    v_exp_f32 v126, v126
    v_exp_f32 v127, v127
    v_mul_f32 v0, v210, v0
    v_mul_f32 v1, v210, v1
    v_mul_f32 v2, v210, v2
    v_mul_f32 v3, v210, v3
    v_mul_f32 v4, v210, v4
    v_mul_f32 v5, v210, v5
    v_mul_f32 v6, v210, v6
    v_mul_f32 v7, v210, v7
    v_mul_f32 v8, v210, v8
    v_mul_f32 v9, v210, v9
    v_mul_f32 v10, v210, v10
    v_mul_f32 v11, v210, v11
    v_mul_f32 v12, v210, v12
    v_mul_f32 v13, v210, v13
    v_mul_f32 v14, v210, v14
    v_mul_f32 v15, v210, v15
    v_mul_f32 v16, v210, v16
    v_mul_f32 v17, v210, v17
    v_mul_f32 v18, v210, v18
    v_mul_f32 v19, v210, v19
    v_mul_f32 v20, v210, v20
    v_mul_f32 v21, v210, v21
    v_mul_f32 v22, v210, v22
    v_mul_f32 v23, v210, v23
    v_mul_f32 v24, v210, v24
    v_mul_f32 v25, v210, v25
    v_mul_f32 v26, v210, v26
    v_mul_f32 v27, v210, v27
    v_mul_f32 v28, v210, v28
    v_mul_f32 v29, v210, v29
    v_mul_f32 v30, v210, v30
    v_mul_f32 v31, v210, v31
    v_mul_f32 v32, v210, v32
    v_mul_f32 v33, v210, v33
    v_mul_f32 v34, v210, v34
    v_mul_f32 v35, v210, v35
    v_mul_f32 v36, v210, v36
    v_mul_f32 v37, v210, v37
    v_mul_f32 v38, v210, v38
    v_mul_f32 v39, v210, v39
    v_mul_f32 v40, v210, v40
    v_mul_f32 v41, v210, v41
    v_mul_f32 v42, v210, v42
    v_mul_f32 v43, v210, v43
    v_mul_f32 v44, v210, v44
    v_mul_f32 v45, v210, v45
    v_mul_f32 v46, v210, v46
    v_mul_f32 v47, v210, v47
    v_mul_f32 v48, v210, v48
    v_mul_f32 v49, v210, v49
    v_mul_f32 v50, v210, v50
    v_mul_f32 v51, v210, v51
    v_mul_f32 v52, v210, v52
    v_mul_f32 v53, v210, v53
    v_mul_f32 v54, v210, v54
    v_mul_f32 v55, v210, v55
    v_mul_f32 v56, v210, v56
    v_mul_f32 v57, v210, v57
    v_mul_f32 v58, v210, v58
    v_mul_f32 v59, v210, v59
    v_mul_f32 v60, v210, v60
    v_mul_f32 v61, v210, v61
    v_mul_f32 v62, v210, v62
    v_mul_f32 v63, v210, v63
    v_mul_f32 v200, v210, v200
    v_mul_f32 v201, v210, v201
    v_mul_f32 v202, v210, v202
    v_mul_f32 v203, v210, v203
    v_cvt_pk_bf16_f32 v128, v112, v113
    v_cvt_pk_bf16_f32 v129, v114, v115
    v_cvt_pk_bf16_f32 v130, v116, v117
    v_cvt_pk_bf16_f32 v131, v118, v119
    v_cvt_pk_bf16_f32 v132, v120, v121
    v_cvt_pk_bf16_f32 v133, v122, v123
    v_cvt_pk_bf16_f32 v134, v124, v125
    v_cvt_pk_bf16_f32 v135, v126, v127
    s_waitcnt vmcnt(0)
    ds_read_b64_tr_b16 v[168:169], v209 offset:0
    ds_read_b64_tr_b16 v[170:171], v209 offset:512
    ds_read_b64_tr_b16 v[172:173], v209 offset:64
    ds_read_b64_tr_b16 v[174:175], v209 offset:576
    ds_read_b64_tr_b16 v[176:177], v209 offset:128
    ds_read_b64_tr_b16 v[178:179], v209 offset:640
    ds_read_b64_tr_b16 v[180:181], v209 offset:192
    ds_read_b64_tr_b16 v[182:183], v209 offset:704
    s_waitcnt lgkmcnt(0)
    ds_read_b64_tr_b16 v[184:185], v209 offset:4352
    ds_read_b64_tr_b16 v[186:187], v209 offset:4864
    ds_read_b64_tr_b16 v[188:189], v209 offset:4416
    ds_read_b64_tr_b16 v[190:191], v209 offset:4928
    ds_read_b64_tr_b16 v[192:193], v209 offset:4480
    ds_read_b64_tr_b16 v[194:195], v209 offset:4992
    ds_read_b64_tr_b16 v[196:197], v209 offset:4544
    ds_read_b64_tr_b16 v[198:199], v209 offset:5056
    v_mfma_f32_32x32x16_bf16 v[0:15], v[168:171], v[128:131], v[0:15]
    v_mfma_f32_32x32x16_bf16 v[16:31], v[172:175], v[128:131], v[16:31]
    v_mfma_f32_32x32x16_bf16 v[32:47], v[176:179], v[128:131], v[32:47]
    v_mfma_f32_32x32x16_bf16 v[48:63], v[180:183], v[128:131], v[48:63]
    v_mfma_f32_16x16x32_bf16 v[200:203], v[204:207], v[128:131], v[200:203]
    s_waitcnt lgkmcnt(0)
    v_mfma_f32_32x32x16_bf16 v[0:15], v[184:187], v[132:135], v[0:15]
    v_mfma_f32_32x32x16_bf16 v[16:31], v[188:191], v[132:135], v[16:31]
    v_mfma_f32_32x32x16_bf16 v[32:47], v[192:195], v[132:135], v[32:47]
    v_mfma_f32_32x32x16_bf16 v[48:63], v[196:199], v[132:135], v[48:63]
    v_mfma_f32_16x16x32_bf16 v[200:203], v[204:207], v[132:135], v[200:203]
    s_sub_u32 s23, s23, 0x8000
    s_add_u32 s42, s42, 1
    s_cmp_lt_u32 s42, s22
    s_cbranch_scc1 L_slow_loop
    s_nop 15
    v_xor_b32 v233, 16, v240
    v_xor_b32 v234, 32, v240
    v_xor_b32 v235, 48, v240
    v_rcp_f32 v237, v200
    s_branch L_norm
.p2align 6
.type L_table,@object
L_table:
.long 0x1c100fbe, 0x00000000
.long 0x1c102fbe, 0x00000000
.long 0x1c104fbe, 0x00000000
.long 0x1c106fbe, 0x00000000
.long 0x180f0a95, 0x00000000
.long 0x180f2a95, 0x00000000
.long 0x180f4a95, 0x00000000
.long 0x180f6a95, 0x00000000
.long 0x200f0f9e, 0x00000000
.long 0x200f2f9e, 0x00000000
.long 0x200f4f9e, 0x00000000
.long 0x200f6f9e, 0x00000000
.long 0x200e0a75, 0x00000000
.long 0x200e2a75, 0x00000000
.long 0x200e4a75, 0x00000000
.long 0x200e6a75, 0x00000000
.long 0x200e0f7e, 0x00000000
.long 0x200e2f7e, 0x00000000
.long 0x200e4f7e, 0x00000000
.long 0x200e6f7e, 0x00000000
.long 0x200d0a55, 0x00000000
.long 0x200d2a55, 0x00000000
.long 0x200d4a55, 0x00000000
.long 0x200d6a55, 0x00000000
.long 0x200d0f5e, 0x00000000
.long 0x200d2f5e, 0x00000000
.long 0x200d4f5e, 0x00000000
.long 0x200d6f5e, 0x00000000
.long 0x1b0d045e, 0x00000000
.long 0x1b0d245e, 0x00000000
.long 0x1b0d445e, 0x00000000
.long 0x1b0d645e, 0x00000000
.long 0x200c0f3e, 0x00000000
.long 0x200c2f3e, 0x00000000
.long 0x200c4f3e, 0x00000000
.long 0x200c6f3e, 0x00000000
.long 0x200c0a35, 0x00000000
.long 0x200c2a35, 0x00000000
.long 0x200c4a35, 0x00000000
.long 0x200c6a35, 0x00000000
.long 0x200b0f1e, 0x00000000
.long 0x200b2f1e, 0x00000000
.long 0x200b4f1e, 0x00000000
.long 0x200b6f1e, 0x00000000
.long 0x200c043e, 0x00000000
.long 0x200c243e, 0x00000000
.long 0x200c443e, 0x00000000
.long 0x200c643e, 0x00000000
.long 0x170b02c7, 0x00000000
.long 0x170b22c7, 0x00000000
.long 0x170b42c7, 0x00000000
.long 0x170b62c7, 0x00000000
.long 0x200b0a15, 0x00000000
.long 0x200b2a15, 0x00000000
.long 0x200b4a15, 0x00000000
.long 0x200b6a15, 0x00000000
.long 0x150b05b9, 0x00000000
.long 0x150b25b9, 0x00000000
.long 0x150b45b9, 0x00000000
.long 0x150b65b9, 0x00000000
.long 0x200b041e, 0x00000000
.long 0x200b241e, 0x00000000
.long 0x200b441e, 0x00000000
.long 0x200b641e, 0x00000000
.long 0x200a0efe, 0x00000000
.long 0x200a2efe, 0x00000000
.long 0x200a4efe, 0x00000000
.long 0x200a6efe, 0x00000000
.long 0x150b08c0, 0x00000000
.long 0x150b28c0, 0x00000000
.long 0x150b48c0, 0x00000000
.long 0x150b68c0, 0x00000000
.long 0x200a02a7, 0x00000000
.long 0x200a22a7, 0x00000000
.long 0x200a42a7, 0x00000000
.long 0x200a62a7, 0x00000000
.long 0x200a09f5, 0x00000000
.long 0x200a29f5, 0x00000000
.long 0x200a49f5, 0x00000000
.long 0x200a69f5, 0x00000000
.long 0x200a0599, 0x00000000
.long 0x200a2599, 0x00000000
.long 0x200a4599, 0x00000000
.long 0x200a6599, 0x00000000
.long 0x200a03fe, 0x00000000
.long 0x200a23fe, 0x00000000
.long 0x200a43fe, 0x00000000
.long 0x200a63fe, 0x00000000
.long 0x0a0a0cc2, 0x00000000
.long 0x0a0a2cc2, 0x00000000
.long 0x0a0a4cc2, 0x00000000
.long 0x0a0a6cc2, 0x00000000
.long 0x200a08a0, 0x00000000
.long 0x200a28a0, 0x00000000
.long 0x200a48a0, 0x00000000
.long 0x200a68a0, 0x00000000
.long 0x20090ede, 0x00000000
.long 0x20092ede, 0x00000000
.long 0x20094ede, 0x00000000
.long 0x20096ede, 0x00000000
.long 0x200909d5, 0x00000000
.long 0x200929d5, 0x00000000
.long 0x200949d5, 0x00000000
.long 0x200969d5, 0x00000000
.long 0x20090287, 0x00000000
.long 0x20092287, 0x00000000
.long 0x20094287, 0x00000000
.long 0x20096287, 0x00000000
.long 0x200903de, 0x00000000
.long 0x200923de, 0x00000000
.long 0x200943de, 0x00000000
.long 0x200963de, 0x00000000
.long 0x20090579, 0x00000000
.long 0x20092579, 0x00000000
.long 0x20094579, 0x00000000
.long 0x20096579, 0x00000000
.long 0x20090880, 0x00000000
.long 0x20092880, 0x00000000
.long 0x20094880, 0x00000000
.long 0x20096880, 0x00000000
.long 0x20090ca2, 0x00000000
.long 0x20092ca2, 0x00000000
.long 0x20094ca2, 0x00000000
.long 0x20096ca2, 0x00000000
.long 0x12090dcc, 0x00000000
.long 0x12092dcc, 0x00000000
.long 0x12094dcc, 0x00000000
.long 0x12096dcc, 0x00000000
.long 0x20080ebe, 0x00000000
.long 0x20082ebe, 0x00000000
.long 0x20084ebe, 0x00000000
.long 0x20086ebe, 0x00000000
.long 0x0b090100, 0x00000000
.long 0x0b092100, 0x00000000
.long 0x0b094100, 0x00000000
.long 0x0b096100, 0x00000000
.long 0x20080267, 0x00000000
.long 0x20082267, 0x00000000
.long 0x20084267, 0x00000000
.long 0x20086267, 0x00000000
.long 0x200809b5, 0x00000000
.long 0x200829b5, 0x00000000
.long 0x200849b5, 0x00000000
.long 0x200869b5, 0x00000000
.long 0x20080559, 0x00000000
.long 0x20082559, 0x00000000
.long 0x20084559, 0x00000000
.long 0x20086559, 0x00000000
.long 0x200803be, 0x00000000
.long 0x200823be, 0x00000000
.long 0x200843be, 0x00000000
.long 0x200863be, 0x00000000
.long 0x20080c82, 0x00000000
.long 0x20082c82, 0x00000000
.long 0x20084c82, 0x00000000
.long 0x20086c82, 0x00000000
.long 0x20080860, 0x00000000
.long 0x20082860, 0x00000000
.long 0x20084860, 0x00000000
.long 0x20086860, 0x00000000
.long 0x20070e9e, 0x00000000
.long 0x20072e9e, 0x00000000
.long 0x20074e9e, 0x00000000
.long 0x20076e9e, 0x00000000
.long 0x200800e0, 0x00000000
.long 0x200820e0, 0x00000000
.long 0x200840e0, 0x00000000
.long 0x200860e0, 0x00000000
.long 0x20070247, 0x00000000
.long 0x20072247, 0x00000000
.long 0x20074247, 0x00000000
.long 0x20076247, 0x00000000
.long 0x20080dac, 0x00000000
.long 0x20082dac, 0x00000000
.long 0x20084dac, 0x00000000
.long 0x20086dac, 0x00000000
.long 0x20070539, 0x00000000
.long 0x20072539, 0x00000000
.long 0x20074539, 0x00000000
.long 0x20076539, 0x00000000
.long 0x20070995, 0x00000000
.long 0x20072995, 0x00000000
.long 0x20074995, 0x00000000
.long 0x20076995, 0x00000000
.long 0x20070c62, 0x00000000
.long 0x20072c62, 0x00000000
.long 0x20074c62, 0x00000000
.long 0x20076c62, 0x00000000
.long 0x2007039e, 0x00000000
.long 0x2007239e, 0x00000000
.long 0x2007439e, 0x00000000
.long 0x2007639e, 0x00000000
.long 0x0f0706f2, 0x00000000
.long 0x0f0726f2, 0x00000000
.long 0x0f0746f2, 0x00000000
.long 0x0f0766f2, 0x00000000
.long 0x20070840, 0x00000000
.long 0x20072840, 0x00000000
.long 0x20074840, 0x00000000
.long 0x20076840, 0x00000000
.long 0x20060e7e, 0x00000000
.long 0x20062e7e, 0x00000000
.long 0x20064e7e, 0x00000000
.long 0x20066e7e, 0x00000000
.long 0x200700c0, 0x00000000
.long 0x200720c0, 0x00000000
.long 0x200740c0, 0x00000000
.long 0x200760c0, 0x00000000
.long 0x20060227, 0x00000000
.long 0x20062227, 0x00000000
.long 0x20064227, 0x00000000
.long 0x20066227, 0x00000000
.long 0x20070d8c, 0x00000000
.long 0x20072d8c, 0x00000000
.long 0x20074d8c, 0x00000000
.long 0x20076d8c, 0x00000000
.long 0x20010dde, 0x20010fda
.long 0x20012dde, 0x20012fda
.long 0x20014dde, 0x20014fda
.long 0x20016dde, 0x20016fda
.long 0x200108d5, 0x2001010b
.long 0x200128d5, 0x2001210b
.long 0x200148d5, 0x2001410b
.long 0x200168d5, 0x2001610b
.long 0x20020acd, 0x20010632
.long 0x20022acd, 0x20012632
.long 0x20024acd, 0x20014632
.long 0x20026acd, 0x20016632
.long 0x20020b4c, 0x20010ccc
.long 0x20022b4c, 0x20012ccc
.long 0x20024b4c, 0x20014ccc
.long 0x20026b4c, 0x20016ccc
.long 0x200205ee, 0x20010ba2
.long 0x200225ee, 0x20012ba2
.long 0x200245ee, 0x20014ba2
.long 0x200265ee, 0x20016ba2
.long 0x20020721, 0x20010000
.long 0x20022721, 0x20012000
.long 0x20024721, 0x20014000
.long 0x20026721, 0x20016000
.long 0x20020ffa, 0x20010479
.long 0x20022ffa, 0x20012479
.long 0x20024ffa, 0x20014479
.long 0x20026ffa, 0x20016479
.long 0x2002012b, 0x20010780
.long 0x2002212b, 0x20012780
.long 0x2002412b, 0x20014780
.long 0x2002612b, 0x20016780
.long 0x20020652, 0x20010187
.long 0x20022652, 0x20012187
.long 0x20024652, 0x20014187
.long 0x20026652, 0x20016187
.long 0x20020cec, 0x200102de
.long 0x20022cec, 0x200122de
.long 0x20024cec, 0x200142de
.long 0x20026cec, 0x200162de
.long 0xa00105ce, 0x00000000
.long 0xa00125ce, 0x00000000
.long 0xa00145ce, 0x00000000
.long 0xa00165ce, 0x00000000
.long 0xa0010701, 0x00000000
.long 0xa0012701, 0x00000000
.long 0xa0014701, 0x00000000
.long 0xa0016701, 0x00000000
.long 0xa0010aad, 0x00000000
.long 0xa0012aad, 0x00000000
.long 0xa0014aad, 0x00000000
.long 0xa0016aad, 0x00000000
.long 0xa0010b2c, 0x00000000
.long 0xa0012b2c, 0x00000000
.long 0xa0014b2c, 0x00000000
.long 0xa0016b2c, 0x00000000
.long 0xa0020bc2, 0x00000000
.long 0xa0022bc2, 0x00000000
.long 0xa0024bc2, 0x00000000
.long 0xa0026bc2, 0x00000000
.long 0xa0020020, 0x00000000
.long 0xa0022020, 0x00000000
.long 0xa0024020, 0x00000000
.long 0xa0026020, 0x00000000
.long 0xa0020499, 0x00000000
.long 0xa0022499, 0x00000000
.long 0xa0024499, 0x00000000
.long 0xa0026499, 0x00000000
.long 0xa00207a0, 0x00000000
.long 0xa00227a0, 0x00000000
.long 0xa00247a0, 0x00000000
.long 0xa00267a0, 0x00000000
.long 0xa00201a7, 0x00000000
.long 0xa00221a7, 0x00000000
.long 0xa00241a7, 0x00000000
.long 0xa00261a7, 0x00000000
.long 0xa00202fe, 0x00000000
.long 0xa00222fe, 0x00000000
.long 0xa00242fe, 0x00000000
.long 0xa00262fe, 0x00000000
.long 0xa0020dfe, 0x00000000
.long 0xa0022dfe, 0x00000000
.long 0xa0024dfe, 0x00000000
.long 0xa0026dfe, 0x00000000
.long 0xa00208f5, 0x00000000
.long 0xa00228f5, 0x00000000
.long 0xa00248f5, 0x00000000
.long 0xa00268f5, 0x00000000
.long 0xa0030aed, 0x00000000
.long 0xa0032aed, 0x00000000
.long 0xa0034aed, 0x00000000
.long 0xa0036aed, 0x00000000
.long 0xa0030b6c, 0x00000000
.long 0xa0032b6c, 0x00000000
.long 0xa0034b6c, 0x00000000
.long 0xa0036b6c, 0x00000000
.long 0xa003060e, 0x00000000
.long 0xa003260e, 0x00000000
.long 0xa003460e, 0x00000000
.long 0xa003660e, 0x00000000
.long 0xa0030741, 0x00000000
.long 0xa0032741, 0x00000000
.long 0xa0034741, 0x00000000
.long 0xa0036741, 0x00000000
.long 0xa003101a, 0x00000000
.long 0xa003301a, 0x00000000
.long 0xa003501a, 0x00000000
.long 0xa003701a, 0x00000000
.long 0xa003014b, 0x00000000
.long 0xa003214b, 0x00000000
.long 0xa003414b, 0x00000000
.long 0xa003614b, 0x00000000
.long 0xa0030672, 0x00000000
.long 0xa0032672, 0x00000000
.long 0xa0034672, 0x00000000
.long 0xa0036672, 0x00000000
.long 0xa0030d0c, 0x00000000
.long 0xa0032d0c, 0x00000000
.long 0xa0034d0c, 0x00000000
.long 0xa0036d0c, 0x00000000
.long 0xa0030be2, 0x00000000
.long 0xa0032be2, 0x00000000
.long 0xa0034be2, 0x00000000
.long 0xa0036be2, 0x00000000
.long 0xa0030040, 0x00000000
.long 0xa0032040, 0x00000000
.long 0xa0034040, 0x00000000
.long 0xa0036040, 0x00000000
.long 0xa00304b9, 0x00000000
.long 0xa00324b9, 0x00000000
.long 0xa00344b9, 0x00000000
.long 0xa00364b9, 0x00000000
.long 0xa00307c0, 0x00000000
.long 0xa00327c0, 0x00000000
.long 0xa00347c0, 0x00000000
.long 0xa00367c0, 0x00000000
.long 0xa00301c7, 0x00000000
.long 0xa00321c7, 0x00000000
.long 0xa00341c7, 0x00000000
.long 0xa00361c7, 0x00000000
.long 0xa003031e, 0x00000000
.long 0xa003231e, 0x00000000
.long 0xa003431e, 0x00000000
.long 0xa003631e, 0x00000000
.long 0xa0030e1e, 0x00000000
.long 0xa0032e1e, 0x00000000
.long 0xa0034e1e, 0x00000000
.long 0xa0036e1e, 0x00000000
.long 0xa0030915, 0x00000000
.long 0xa0032915, 0x00000000
.long 0xa0034915, 0x00000000
.long 0xa0036915, 0x00000000
.long 0x8404062e, 0x00000000
.long 0x8404262e, 0x00000000
.long 0x8404462e, 0x00000000
.long 0x8404662e, 0x00000000
.long 0x96040b8c, 0x00000000
.long 0x96042b8c, 0x00000000
.long 0x96044b8c, 0x00000000
.long 0x96046b8c, 0x00000000
.long 0x9f040b0d, 0x00000000
.long 0x9f042b0d, 0x00000000
.long 0x9f044b0d, 0x00000000
.long 0x9f046b0d, 0x00000000
.long 0x9c04016b, 0x00000000
.long 0x9c04216b, 0x00000000
.long 0x9c04416b, 0x00000000
.long 0x9c04616b, 0x00000000
.long 0xa004103a, 0x00000000
.long 0xa004303a, 0x00000000
.long 0xa004503a, 0x00000000
.long 0xa004703a, 0x00000000
.long 0x9f040761, 0x00000000
.long 0x9f042761, 0x00000000
.long 0x9f044761, 0x00000000
.long 0x9f046761, 0x00000000
.long 0xa0040692, 0x00000000
.long 0xa0042692, 0x00000000
.long 0xa0044692, 0x00000000
.long 0xa0046692, 0x00000000
.long 0xa0040d2c, 0x00000000
.long 0xa0042d2c, 0x00000000
.long 0xa0044d2c, 0x00000000
.long 0xa0046d2c, 0x00000000
.long 0xa0040c02, 0x00000000
.long 0xa0042c02, 0x00000000
.long 0xa0044c02, 0x00000000
.long 0xa0046c02, 0x00000000
.long 0xa0040060, 0x00000000
.long 0xa0042060, 0x00000000
.long 0xa0044060, 0x00000000
.long 0xa0046060, 0x00000000
.long 0xa00404d9, 0x00000000
.long 0xa00424d9, 0x00000000
.long 0xa00444d9, 0x00000000
.long 0xa00464d9, 0x00000000
.long 0xa00407e0, 0x00000000
.long 0xa00427e0, 0x00000000
.long 0xa00447e0, 0x00000000
.long 0xa00467e0, 0x00000000
.long 0xa00401e7, 0x00000000
.long 0xa00421e7, 0x00000000
.long 0xa00441e7, 0x00000000
.long 0xa00461e7, 0x00000000
.long 0xa004033e, 0x00000000
.long 0xa004233e, 0x00000000
.long 0xa004433e, 0x00000000
.long 0xa004633e, 0x00000000
.long 0xa0040e3e, 0x00000000
.long 0xa0042e3e, 0x00000000
.long 0xa0044e3e, 0x00000000
.long 0xa0046e3e, 0x00000000
.long 0xa0040935, 0x00000000
.long 0xa0042935, 0x00000000
.long 0xa0044935, 0x00000000
.long 0xa0046935, 0x00000000
.long 0xa005105a, 0x00000000
.long 0xa005305a, 0x00000000
.long 0xa005505a, 0x00000000
.long 0xa005705a, 0x00000000
.long 0xa0050d4c, 0x00000000
.long 0xa0052d4c, 0x00000000
.long 0xa0054d4c, 0x00000000
.long 0xa0056d4c, 0x00000000
.long 0xa00506b2, 0x00000000
.long 0xa00526b2, 0x00000000
.long 0xa00546b2, 0x00000000
.long 0xa00566b2, 0x00000000
.long 0xa0050080, 0x00000000
.long 0xa0052080, 0x00000000
.long 0xa0054080, 0x00000000
.long 0xa0056080, 0x00000000
.long 0xa0050c22, 0x00000000
.long 0xa0052c22, 0x00000000
.long 0xa0054c22, 0x00000000
.long 0xa0056c22, 0x00000000
.long 0xa0050800, 0x00000000
.long 0xa0052800, 0x00000000
.long 0xa0054800, 0x00000000
.long 0xa0056800, 0x00000000
.long 0xa00504f9, 0x00000000
.long 0xa00524f9, 0x00000000
.long 0xa00544f9, 0x00000000
.long 0xa00564f9, 0x00000000
.long 0xa005035e, 0x00000000
.long 0xa005235e, 0x00000000
.long 0xa005435e, 0x00000000
.long 0xa005635e, 0x00000000
.long 0xa0050207, 0x00000000
.long 0xa0052207, 0x00000000
.long 0xa0054207, 0x00000000
.long 0xa0056207, 0x00000000
.long 0xa0050955, 0x00000000
.long 0xa0052955, 0x00000000
.long 0xa0054955, 0x00000000
.long 0xa0056955, 0x00000000
.long 0xa0050e5e, 0x00000000
.long 0xa0052e5e, 0x00000000
.long 0xa0054e5e, 0x00000000
.long 0xa0056e5e, 0x00000000
.long 0xa0060d6c, 0x00000000
.long 0xa0062d6c, 0x00000000
.long 0xa0064d6c, 0x00000000
.long 0xa0066d6c, 0x00000000
.long 0x9f06107a, 0x00000000
.long 0x9f06307a, 0x00000000
.long 0x9f06507a, 0x00000000
.long 0x9f06707a, 0x00000000
.long 0xa00600a0, 0x00000000
.long 0xa00620a0, 0x00000000
.long 0xa00640a0, 0x00000000
.long 0xa00660a0, 0x00000000
.long 0xa00606d2, 0x00000000
.long 0xa00626d2, 0x00000000
.long 0xa00646d2, 0x00000000
.long 0xa00666d2, 0x00000000
.long 0xa0060820, 0x00000000
.long 0xa0062820, 0x00000000
.long 0xa0064820, 0x00000000
.long 0xa0066820, 0x00000000
.long 0xa0060c42, 0x00000000
.long 0xa0062c42, 0x00000000
.long 0xa0064c42, 0x00000000
.long 0xa0066c42, 0x00000000
.long 0xa006037e, 0x00000000
.long 0xa006237e, 0x00000000
.long 0xa006437e, 0x00000000
.long 0xa006637e, 0x00000000
.long 0xa0060519, 0x00000000
.long 0xa0062519, 0x00000000
.long 0xa0064519, 0x00000000
.long 0xa0066519, 0x00000000
.long 0xa0060975, 0x00000000
.long 0xa0062975, 0x00000000
.long 0xa0064975, 0x00000000
.long 0xa0066975, 0x00000000
.size L_table, 4096
.section .rodata,"a"
.p2align 6
.amdhsa_kernel standalone__ragged_sequences_varlen_flash_attn__ragged_kernel
  .amdhsa_next_free_vgpr 248
  .amdhsa_next_free_sgpr 100
  .amdhsa_accum_offset 248
  .amdhsa_group_segment_fixed_size 0
  .amdhsa_kernarg_size 56
  .amdhsa_user_sgpr_count 2
  .amdhsa_user_sgpr_kernarg_segment_ptr 1
  .amdhsa_system_sgpr_workgroup_id_x 1
.end_amdhsa_kernel
```
